```python
import torch

def _softmax(x, axis=-1):
    return torch.softmax(x, dim=axis)
def _gelu(x):
    return torch.nn.functional.gelu(x, approximate="tanh")
def _silu(x):
    return torch.nn.functional.silu(x)
def _sigmoid(x):
    return torch.sigmoid(x)
def _layernorm(x, axis=-1, eps=1e-5):
    m = x.mean(dim=axis, keepdim=True)
    v = x.var(dim=axis, keepdim=True, unbiased=False)
    return (x - m) / torch.sqrt(v + eps)
def _scatter_add(tgt, idx, src, axis=0):
    return tgt.clone().index_add_(axis, idx, src)
def _segment_sum(src, seg, n):
    out = torch.zeros((n,) + src.shape[1:], dtype=src.dtype)
    return out.index_add_(0, seg, src)
def _pad(x, pw):
    flat = tuple(v for pair in reversed(pw) for v in pair)
    return torch.nn.functional.pad(x, flat)

kernel_name = 'sequential_preLN__mha_block__moe_arch_mod__prompt'

def setup_inputs():

    _w = (lambda a: (lambda t: t.to(torch.bfloat16) if t.is_floating_point() else t)(torch.as_tensor(a)))
    def _A_setup():
        B, S, D, H = 1, 2048, 512, 32
        return {
            "x": _w((lambda *s: torch.randn(*s, dtype=torch.bfloat16) * 0.05)(B, S, D)),
            "wqkv": _w((lambda *s: torch.randn(*s, dtype=torch.bfloat16) * 0.05)(D, 3 * D)),
            "wo": _w((lambda *s: torch.randn(*s, dtype=torch.bfloat16) * 0.05)(D, D)),
        }
    _A_in = _A_setup()

    def _B_setup():
        B, S, D, F, C = 1, 2048, 512, 1376, 8
        return {
            "x": _w((lambda *s: torch.randn(*s, dtype=torch.bfloat16) * 0.05)(B, S, D)),
            "w_r": _w((lambda *s: torch.randn(*s, dtype=torch.bfloat16) * 0.05)(D)),
            "w_gate": _w((lambda *s: torch.randn(*s, dtype=torch.bfloat16) * 0.05)(D, F)),
            "w_up": _w((lambda *s: torch.randn(*s, dtype=torch.bfloat16) * 0.05)(D, F)),
            "w_down": _w((lambda *s: torch.randn(*s, dtype=torch.bfloat16) * 0.05)(F, D)),
        }
    _B_in = _B_setup()

    return {
        "A_x": _A_in["x"],
        "A_wqkv": _A_in["wqkv"],
        "A_wo": _A_in["wo"],
        "B_x": _B_in["x"],
        "B_w_r": _B_in["w_r"],
        "B_w_gate": _B_in["w_gate"],
        "B_w_up": _B_in["w_up"],
        "B_w_down": _B_in["w_down"],
    }

def reference(A_x, A_wqkv, A_wo, B_x, B_w_r, B_w_gate, B_w_up, B_w_down):
    def _A_ref(x, wqkv, wo):
        B, S, D = x.shape
        H = 32
        Dh = D // H
        qkv = (lambda x, *d: x.permute(*d))((x @ wqkv).reshape(B, S, 3, H, Dh), 2, 0, 3, 1, 4)
        q, k, v = qkv[0], qkv[1], qkv[2]
        scores = torch.einsum("bhqd,bhkd->bhqk", q, k) * (Dh ** -0.5)
        p = _softmax(scores, axis=-1)
        o = torch.einsum("bhqk,bhkd->bhqd", p, v)
        return (lambda x, *d: x.permute(*d))(o, 0, 2, 1, 3).reshape(B, S, D) @ wo

    def _B_ref(x, w_r, w_gate, w_up, w_down):
        B, S, D = x.shape
        C = 8
        r = x @ w_r
        idx = torch.argsort(-r, axis=-1)[:, :C]
        idx_e = (lambda x, n, axis: torch.repeat_interleave(x, n, dim=axis))(idx.reshape(B, C, 1), D, axis=2)
        x_sel = (lambda x, i, axis: torch.take_along_dim(x, i, dim=axis))(x, idx_e, axis=1)
        g = _silu(x_sel @ w_gate)
        u = x_sel @ w_up
        y = (g * u) @ w_down
        r_sel = _sigmoid((lambda x, i, axis: torch.take_along_dim(x, i, dim=axis))(r, idx, axis=1))
        y = y * r_sel.reshape(B, C, 1)
        b_off = (torch.arange(B) * S).reshape(B, 1)
        flat_idx = (idx + b_off).reshape(B * C)
        zero = (x * 0.0).reshape(B * S, D)
        upd = _scatter_add(zero, flat_idx, y.reshape(B * C, D), axis=0)
        return x + upd.reshape(B, S, D)

    x = A_x
    h = x + _A_ref(_layernorm(x, axis=-1), A_wqkv, A_wo)
    h2 = h + _B_ref(_layernorm(h, axis=-1), B_w_r, B_w_gate, B_w_up, B_w_down)
    return h2
```

```asm
; @launch grid=(256,1,1) block=(768,1,1) lds=163840
.amdgcn_target "amdgcn-amd-amdhsa--gfx950"
.text
.globl sequential_preLN__mha_block__moe_arch_mod__prompt_kernel
.p2align 8
.type sequential_preLN__mha_block__moe_arch_mod__prompt_kernel,@function
sequential_preLN__mha_block__moe_arch_mod__prompt_kernel:
L_code_start:
    s_getpc_b64 s[6:7]
    s_cmp_ge_u32 s2, 256
    s_cbranch_scc1 L_done
    s_load_dwordx16 s[36:51], s[0:1], 0
    s_load_dwordx2 s[4:5], s[0:1], 64
    s_load_dwordx2 s[8:9], s[0:1], 80
    s_and_b32 s10, s2, 7
    s_lshl_b32 s10, s10, 1
    s_bfe_u32 s11, s2, 0x10003
    s_add_u32 s10, s10, s11
    s_lshr_b32 s11, s2, 4
    v_and_b32 v1, 63, v0
    v_lshrrev_b32 v2, 6, v0
    v_lshlrev_b32 v3, 4, v1
    v_readfirstlane_b32 s12, v2
    v_and_b32 v4, 15, v1
    v_lshrrev_b32 v5, 4, v1
    s_and_b32 s13, s12, 1
    s_lshr_b32 s14, s12, 1
    s_lshl_b32 s15, s10, 1
    s_add_u32 s15, s15, s13
    s_mov_b32 s53, 400000
    s_cmp_ge_u32 s12, 8
    s_cbranch_scc1 L_loader
    s_and_b32 s54, s2, 7
    s_bfe_u32 s55, s2, 0x40003
    s_mul_i32 s100, s54, 11
    s_add_u32 s100, s100, s55
    s_cmp_lt_u32 s55, 11
    s_cselect_b32 s101, 1, 0
    s_cmp_lt_u32 s100, 86
    s_cselect_b32 s101, s101, 0
    s_cmp_lt_u32 s2, 128
    s_cbranch_scc1 L_role_done
    s_lshl_b32 s100, s54, 2
    s_add_u32 s100, s100, s55
    s_cmp_lt_u32 s55, 4
    s_cselect_b32 s101, 2, 0
L_role_done:
    s_lshl_b32 s54, s12, 12
    v_and_b32 v6, 31, v1
    v_lshlrev_b32 v6, 7, v6
    v_add_u32 v6, s54, v6
    s_mov_b32 s54, L_code_end-L_code_start-8
    v_min_u32 v6, s54, v6
    s_waitcnt lgkmcnt(0)
    s_mov_b32 s16, s36
    s_and_b32 s17, s37, 0xffff
    s_mov_b32 s18, 2097152
    s_mov_b32 s19, 0x00020000
    s_mov_b32 s24, s8
    s_and_b32 s25, s9, 0xffff
    s_mov_b32 s26, 16777216
    s_mov_b32 s27, 0x00020000
    s_mov_b32 s28, s4
    s_and_b32 s29, s5, 0xffff
    s_mov_b32 s30, 2097152
    s_mov_b32 s31, 0x00020000
    s_add_u32 s54, s8, 8388608
    s_addc_u32 s55, s9, 0
    s_load_dword s52, s[54:55], 0
    s_lshl_b32 s54, s11, 7
    s_lshl_b32 s55, s10, 3
    s_add_u32 s54, s54, s55
    s_add_u32 s54, s54, s12
    s_lshl_b32 s32, s54, 10
    buffer_load_dwordx4 v[112:115], v3, s[16:19], s32 offen
    global_load_dword v167, v6, s[6:7]
    s_lshl_b32 s35, s54, 4
    s_add_u32 s35, s35, 9306112
    s_barrier
    v_lshrrev_b32 v6, 1, v4
    v_xor_b32 v6, v6, v5
    v_lshlrev_b32 v98, 7, v4
    v_lshl_add_u32 v98, v6, 4, v98
    s_lshl_b32 s54, s12, 11
    v_add_u32 v98, s54, v98
    v_xor_b32 v99, 0x800, v98
    v_lshrrev_b32 v6, 2, v1
    v_lshlrev_b32 v100, 6, v6
    v_and_b32 v6, 3, v1
    v_lshl_add_u32 v100, v6, 3, v100
    v_and_b32 v6, 1, v5
    v_xor_b32 v6, s13, v6
    v_lshl_add_u32 v100, v6, 5, v100
    v_add_u32 v100, 0x4000, v100
    v_mov_b32 v92, 0x3f803f80
    v_mov_b32 v93, 0x3f803f80
    v_mov_b32 v94, 0x3f803f80
    v_mov_b32 v95, 0x3f803f80
    v_lshrrev_b32 v6, 1, v5
    v_and_b32 v7, 1, v5
    v_lshlrev_b32 v104, 4, v4
    v_lshl_add_u32 v105, v7, 8, v104
    v_lshl_add_u32 v105, v6, 3, v105
    v_lshl_add_u32 v104, v6, 9, v104
    v_lshl_add_u32 v104, v7, 3, v104
    s_lshl_b32 s55, s13, 8
    v_add_u32 v104, s55, v104
    s_lshl_b32 s55, s13, 9
    v_add_u32 v105, s55, v105
    s_lshl_b32 s54, s12, 11
    s_add_u32 s54, s54, 98304
    v_add_u32 v106, s54, v104
    v_add_u32 v105, s54, v105
    v_add_u32 v107, s54, v3
    s_lshl_b32 s55, s13, 12
    s_add_u32 s55, s55, 90112
    v_add_u32 v10, s55, v3
    s_lshl_b32 s62, s14, 10
    s_add_u32 s55, s55, s62
    v_add_u32 v104, s55, v104
    v_xor_b32 v108, 0x100, v106
    v_xor_b32 v109, 0x200, v105
    v_xor_b32 v110, 0x100, v104
    v_mov_b32 v15, 0
    v_lshrrev_b32 v13, 5, v1
    v_lshlrev_b32 v12, 8, v13
    v_lshl_add_u32 v12, v4, 4, v12
    v_and_b32 v7, 31, v1
    v_mov_b32 v8, 0x3f803f80
    v_cmp_eq_u32 vcc, 16, v7
    s_mov_b32 s60, 0x0000ffff
    s_mov_b32 s61, 0x0000ffff
    v_cndmask_b32 v8, 0, v8, vcc
    s_add_u32 s54, s54, 1024
    v_add_u32 v11, s54, v12
    v_and_b32 v14, 6, v1
    v_or_b32 v14, s13, v14
    v_lshlrev_b32 v14, 2, v14
    v_add_u32 v14, 114688, v14
    s_lshl_b32 s56, s15, 16
    s_lshl_b32 s54, s14, 10
    s_add_u32 s56, s56, s54
    s_add_u32 s57, s56, 2097152
    s_lshl_b32 s54, s11, 12
    s_add_u32 s33, s56, s54
    s_add_u32 s34, s57, s54
    s_lshl_b32 s54, s15, 10
    s_lshl_b32 s55, s14, 8
    s_add_u32 s54, s54, s55
    s_add_u32 s63, s54, 8392704
    s_mov_b64 exec, 1
    buffer_load_dword v164, v3, s[24:27], s33 offen sc1
    buffer_load_dword v165, v3, s[24:27], s34 offen sc1
    buffer_load_dword v166, v3, s[24:27], s63 offen sc1
    s_mov_b64 exec, -1
    v_mov_b32 v144, v8
    v_mov_b32 v145, v8
    v_mov_b32 v146, v8
    v_mov_b32 v147, v8
    v_mov_b32 v148, v8
    v_mov_b32 v149, v8
    v_mov_b32 v150, v8
    v_mov_b32 v151, v8
    v_mov_b32 v152, v8
    v_mov_b32 v153, v8
    v_mov_b32 v154, v8
    v_mov_b32 v155, v8
    v_mov_b32 v156, v8
    v_mov_b32 v157, v8
    v_mov_b32 v158, v8
    v_mov_b32 v159, v8
    v_mov_b32 v160, 0
    v_mov_b32 v161, 0
    v_mov_b32 v162, 0
    v_mov_b32 v163, 0
    v_mov_b32 v96, 162816
    v_mov_b32 v97, 1
    v_add_u32 v101, 0, v98
    v_add_u32 v102, 0, v99
    v_add_u32 v103, 0, v100
    s_waitcnt lgkmcnt(0)
L_lc_1:
    ds_read_b32 v111, v96 offset:576
    s_waitcnt lgkmcnt(0)
    v_readfirstlane_b32 s54, v111
    s_cmp_lt_u32 s54, 4
    s_cbranch_scc1 L_lc_1
L_lok_2:
    ds_read_b128 v[40:43], v101
    ds_read_b128 v[44:47], v102
    ds_read_b64_tr_b16 v[56:57], v103 offset:0
    ds_read_b64_tr_b16 v[58:59], v103 offset:1024
    ds_read_b64_tr_b16 v[60:61], v103 offset:4096
    ds_read_b64_tr_b16 v[62:63], v103 offset:5120
    ds_read_b64_tr_b16 v[64:65], v103 offset:8192
    ds_read_b64_tr_b16 v[66:67], v103 offset:9216
    v_xor_b32 v8, 64, v101
    v_xor_b32 v9, 64, v102
    s_add_u32 s52, s52, 1
    ds_read_b128 v[48:51], v8
    ds_read_b128 v[52:55], v9
    ds_read_b64_tr_b16 v[68:69], v103 offset:2048
    ds_read_b64_tr_b16 v[70:71], v103 offset:3072
    ds_read_b64_tr_b16 v[72:73], v103 offset:6144
    ds_read_b64_tr_b16 v[74:75], v103 offset:7168
    ds_read_b64_tr_b16 v[76:77], v103 offset:10240
    ds_read_b64_tr_b16 v[78:79], v103 offset:11264
    s_waitcnt lgkmcnt(8)
    ds_read_b32 v111, v96 offset:580
    v_mfma_f32_16x16x32_bf16 v[20:23], v[60:63], v[40:43], 0
    v_mfma_f32_16x16x32_bf16 v[24:27], v[40:43], v[64:67], 0
    v_mfma_f32_16x16x32_bf16 v[16:19], v[56:59], v[40:43], 0
    v_mfma_f32_16x16x32_bf16 v[32:35], v[60:63], v[44:47], 0
    v_mfma_f32_16x16x32_bf16 v[36:39], v[44:47], v[64:67], 0
    v_mfma_f32_16x16x32_bf16 v[28:31], v[56:59], v[44:47], 0
    s_lshr_b32 s54, s11, 3
    s_lshl_b32 s55, s14, 1
    s_or_b32 s54, s54, s55
    s_cmp_eq_u32 s54, 0
    s_cbranch_scc0 L_ws_3
    v_mfma_f32_16x16x32_bf16 v[80:83], v[92:95], v[56:59], 0
    v_mfma_f32_16x16x32_bf16 v[84:87], v[92:95], v[60:63], 0
    v_mfma_f32_16x16x32_bf16 v[88:91], v[92:95], v[64:67], 0
L_ws_3:
    v_add_u32 v101, 28672, v98
    v_add_u32 v102, 28672, v99
    v_add_u32 v103, 28672, v100
    s_waitcnt lgkmcnt(0)
    s_mov_b64 exec, 1
    ds_add_u32 v96, v97 offset:644
    s_mov_b64 exec, -1
    v_readfirstlane_b32 s54, v111
    s_cmp_ge_u32 s54, 4
    s_cbranch_scc1 L_lok_5
L_lc_4:
    ds_read_b32 v111, v96 offset:580
    s_waitcnt lgkmcnt(0)
    v_readfirstlane_b32 s54, v111
    s_cmp_lt_u32 s54, 4
    s_cbranch_scc1 L_lc_4
L_lok_5:
    ds_read_b128 v[40:43], v101
    ds_read_b128 v[44:47], v102
    ds_read_b64_tr_b16 v[56:57], v103 offset:0
    ds_read_b64_tr_b16 v[58:59], v103 offset:1024
    ds_read_b64_tr_b16 v[60:61], v103 offset:4096
    ds_read_b64_tr_b16 v[62:63], v103 offset:5120
    ds_read_b64_tr_b16 v[64:65], v103 offset:8192
    ds_read_b64_tr_b16 v[66:67], v103 offset:9216
    v_xor_b32 v8, 64, v101
    v_xor_b32 v9, 64, v102
    v_mfma_f32_16x16x32_bf16 v[20:23], v[72:75], v[48:51], v[20:23]
    v_mfma_f32_16x16x32_bf16 v[24:27], v[48:51], v[76:79], v[24:27]
    v_mfma_f32_16x16x32_bf16 v[16:19], v[68:71], v[48:51], v[16:19]
    v_mfma_f32_16x16x32_bf16 v[32:35], v[72:75], v[52:55], v[32:35]
    v_mfma_f32_16x16x32_bf16 v[36:39], v[52:55], v[76:79], v[36:39]
    v_mfma_f32_16x16x32_bf16 v[28:31], v[68:71], v[52:55], v[28:31]
    s_lshr_b32 s54, s11, 3
    s_lshl_b32 s55, s14, 1
    s_or_b32 s54, s54, s55
    s_cmp_eq_u32 s54, 1
    s_cbranch_scc0 L_ws_6
    v_mfma_f32_16x16x32_bf16 v[80:83], v[92:95], v[68:71], 0
    v_mfma_f32_16x16x32_bf16 v[84:87], v[92:95], v[72:75], 0
    v_mfma_f32_16x16x32_bf16 v[88:91], v[92:95], v[76:79], 0
L_ws_6:
    v_mov_b32 v116, 0
    v_mov_b32 v117, 0
    s_waitcnt vmcnt(4)
    v_dot2_f32_bf16 v116, v112, v92, v116
    v_dot2_f32_bf16 v117, v112, v112, v117
    v_dot2_f32_bf16 v116, v113, v92, v116
    v_dot2_f32_bf16 v117, v113, v113, v117
    v_dot2_f32_bf16 v116, v114, v92, v116
    v_dot2_f32_bf16 v117, v114, v114, v117
    v_dot2_f32_bf16 v116, v115, v92, v116
    v_dot2_f32_bf16 v117, v115, v115, v117
    s_nop 2
    v_add_f32_dpp v116, v116, v116 row_ror:1 row_mask:0xf bank_mask:0xf
    v_add_f32_dpp v117, v117, v117 row_ror:1 row_mask:0xf bank_mask:0xf
    s_nop 0
    v_add_f32_dpp v116, v116, v116 row_ror:2 row_mask:0xf bank_mask:0xf
    v_add_f32_dpp v117, v117, v117 row_ror:2 row_mask:0xf bank_mask:0xf
    s_nop 0
    v_add_f32_dpp v116, v116, v116 row_ror:4 row_mask:0xf bank_mask:0xf
    v_add_f32_dpp v117, v117, v117 row_ror:4 row_mask:0xf bank_mask:0xf
    s_nop 0
    v_add_f32_dpp v116, v116, v116 row_ror:8 row_mask:0xf bank_mask:0xf
    v_add_f32_dpp v117, v117, v117 row_ror:8 row_mask:0xf bank_mask:0xf
    s_nop 0
    v_mov_b32 v6, v116
    s_nop 1
    v_permlane16_swap_b32 v116, v6
    v_add_f32 v116, v116, v6
    v_mov_b32 v6, v116
    s_nop 1
    v_permlane32_swap_b32 v116, v6
    v_add_f32 v116, v116, v6
    v_mov_b32 v6, v117
    s_nop 1
    v_permlane16_swap_b32 v117, v6
    v_add_f32 v117, v117, v6
    v_mov_b32 v6, v117
    s_nop 1
    v_permlane32_swap_b32 v117, v6
    v_add_f32 v117, v117, v6
    v_mul_f32 v120, 0x3b000000, v116
    v_mul_f32 v6, 0x3b000000, v117
    v_fma_f32 v6, -v120, v120, v6
    v_max_f32 v6, 0, v6
    v_cvt_pk_bf16_f32 v6, v6, v6
    v_and_b32 v6, 0xffff0000, v6
    v_add_f32 v6, 0x3727c5ac, v6
    v_cvt_pk_bf16_f32 v6, v6, v6
    v_and_b32 v6, 0xffff0000, v6
    v_sqrt_f32 v6, v6
    s_nop 0
    v_cvt_pk_bf16_f32 v121, v6, v6
    v_and_b32 v121, 0xffff0000, v121
    v_cvt_pk_bf16_f32 v120, v120, v120
    v_and_b32 v120, 0xffff0000, v120
    v_rcp_f32 v121, v121
    v_mov_b32 v122, s52
    v_mov_b32 v123, s52
    v_mov_b32 v6, 0
    s_mov_b64 exec, 1
    buffer_store_dwordx4 v[120:123], v6, s[24:27], s35 offen sc1
    s_mov_b64 exec, -1
    ds_read_b128 v[48:51], v8
    ds_read_b128 v[52:55], v9
    ds_read_b64_tr_b16 v[68:69], v103 offset:2048
    ds_read_b64_tr_b16 v[70:71], v103 offset:3072
    ds_read_b64_tr_b16 v[72:73], v103 offset:6144
    ds_read_b64_tr_b16 v[74:75], v103 offset:7168
    ds_read_b64_tr_b16 v[76:77], v103 offset:10240
    ds_read_b64_tr_b16 v[78:79], v103 offset:11264
    s_waitcnt lgkmcnt(8)
    ds_read_b32 v111, v96 offset:584
    v_mfma_f32_16x16x32_bf16 v[20:23], v[60:63], v[40:43], v[20:23]
    v_mfma_f32_16x16x32_bf16 v[24:27], v[40:43], v[64:67], v[24:27]
    v_mfma_f32_16x16x32_bf16 v[16:19], v[56:59], v[40:43], v[16:19]
    v_mfma_f32_16x16x32_bf16 v[32:35], v[60:63], v[44:47], v[32:35]
    v_mfma_f32_16x16x32_bf16 v[36:39], v[44:47], v[64:67], v[36:39]
    v_mfma_f32_16x16x32_bf16 v[28:31], v[56:59], v[44:47], v[28:31]
    v_add_u32 v101, 57344, v98
    v_add_u32 v102, 57344, v99
    v_add_u32 v103, 57344, v100
    s_waitcnt lgkmcnt(0)
    s_mov_b64 exec, 1
    ds_add_u32 v96, v97 offset:648
    s_mov_b64 exec, -1
    v_readfirstlane_b32 s54, v111
    s_cmp_ge_u32 s54, 4
    s_cbranch_scc1 L_lok_8
L_lc_7:
    ds_read_b32 v111, v96 offset:584
    s_waitcnt lgkmcnt(0)
    v_readfirstlane_b32 s54, v111
    s_cmp_lt_u32 s54, 4
    s_cbranch_scc1 L_lc_7
L_lok_8:
    s_cmp_lg_u32 s14, 0
    s_cbranch_scc1 L_wp_9
    v_mov_b32 v81, v84
    v_mov_b32 v82, v88
    v_mov_b32 v83, s52
    s_lshl_b32 s54, s15, 12
    s_lshl_b32 s55, s11, 8
    s_add_u32 s54, s54, s55
    s_add_u32 s54, s54, 9371648
    s_mov_b64 exec, 0xffff
    buffer_store_dwordx4 v[80:83], v3, s[24:27], s54 offen sc1
    s_mov_b64 exec, -1
L_wp_9:
    ds_read_b128 v[40:43], v101
    ds_read_b128 v[44:47], v102
    ds_read_b64_tr_b16 v[56:57], v103 offset:0
    ds_read_b64_tr_b16 v[58:59], v103 offset:1024
    ds_read_b64_tr_b16 v[60:61], v103 offset:4096
    ds_read_b64_tr_b16 v[62:63], v103 offset:5120
    ds_read_b64_tr_b16 v[64:65], v103 offset:8192
    ds_read_b64_tr_b16 v[66:67], v103 offset:9216
    v_xor_b32 v8, 64, v101
    v_xor_b32 v9, 64, v102
    v_mfma_f32_16x16x32_bf16 v[20:23], v[72:75], v[48:51], v[20:23]
    v_mfma_f32_16x16x32_bf16 v[24:27], v[48:51], v[76:79], v[24:27]
    v_mfma_f32_16x16x32_bf16 v[16:19], v[68:71], v[48:51], v[16:19]
    v_mfma_f32_16x16x32_bf16 v[32:35], v[72:75], v[52:55], v[32:35]
    v_mfma_f32_16x16x32_bf16 v[36:39], v[52:55], v[76:79], v[36:39]
    v_mfma_f32_16x16x32_bf16 v[28:31], v[68:71], v[52:55], v[28:31]
    ds_read_b128 v[48:51], v8
    ds_read_b128 v[52:55], v9
    ds_read_b64_tr_b16 v[68:69], v103 offset:2048
    ds_read_b64_tr_b16 v[70:71], v103 offset:3072
    ds_read_b64_tr_b16 v[72:73], v103 offset:6144
    ds_read_b64_tr_b16 v[74:75], v103 offset:7168
    ds_read_b64_tr_b16 v[76:77], v103 offset:10240
    ds_read_b64_tr_b16 v[78:79], v103 offset:11264
    s_waitcnt lgkmcnt(8)
    ds_read_b32 v111, v96 offset:588
    v_mfma_f32_16x16x32_bf16 v[20:23], v[60:63], v[40:43], v[20:23]
    v_mfma_f32_16x16x32_bf16 v[24:27], v[40:43], v[64:67], v[24:27]
    v_mfma_f32_16x16x32_bf16 v[16:19], v[56:59], v[40:43], v[16:19]
    v_mfma_f32_16x16x32_bf16 v[32:35], v[60:63], v[44:47], v[32:35]
    v_mfma_f32_16x16x32_bf16 v[36:39], v[44:47], v[64:67], v[36:39]
    v_mfma_f32_16x16x32_bf16 v[28:31], v[56:59], v[44:47], v[28:31]
    v_add_u32 v101, 86016, v98
    v_add_u32 v102, 86016, v99
    v_add_u32 v103, 86016, v100
    s_waitcnt lgkmcnt(0)
    s_mov_b64 exec, 1
    ds_add_u32 v96, v97 offset:652
    s_mov_b64 exec, -1
    v_readfirstlane_b32 s54, v111
    s_cmp_ge_u32 s54, 4
    s_cbranch_scc1 L_lok_11
L_lc_10:
    ds_read_b32 v111, v96 offset:588
    s_waitcnt lgkmcnt(0)
    v_readfirstlane_b32 s54, v111
    s_cmp_lt_u32 s54, 4
    s_cbranch_scc1 L_lc_10
L_lok_11:
    ds_read_b128 v[40:43], v101
    ds_read_b128 v[44:47], v102
    ds_read_b64_tr_b16 v[56:57], v103 offset:0
    ds_read_b64_tr_b16 v[58:59], v103 offset:1024
    ds_read_b64_tr_b16 v[60:61], v103 offset:4096
    ds_read_b64_tr_b16 v[62:63], v103 offset:5120
    ds_read_b64_tr_b16 v[64:65], v103 offset:8192
    ds_read_b64_tr_b16 v[66:67], v103 offset:9216
    v_xor_b32 v8, 64, v101
    v_xor_b32 v9, 64, v102
    v_mfma_f32_16x16x32_bf16 v[20:23], v[72:75], v[48:51], v[20:23]
    v_mfma_f32_16x16x32_bf16 v[24:27], v[48:51], v[76:79], v[24:27]
    v_mfma_f32_16x16x32_bf16 v[16:19], v[68:71], v[48:51], v[16:19]
    v_mfma_f32_16x16x32_bf16 v[32:35], v[72:75], v[52:55], v[32:35]
    v_mfma_f32_16x16x32_bf16 v[36:39], v[52:55], v[76:79], v[36:39]
    v_mfma_f32_16x16x32_bf16 v[28:31], v[68:71], v[52:55], v[28:31]
    ds_read_b128 v[48:51], v8
    ds_read_b128 v[52:55], v9
    ds_read_b64_tr_b16 v[68:69], v103 offset:2048
    ds_read_b64_tr_b16 v[70:71], v103 offset:3072
    ds_read_b64_tr_b16 v[72:73], v103 offset:6144
    ds_read_b64_tr_b16 v[74:75], v103 offset:7168
    ds_read_b64_tr_b16 v[76:77], v103 offset:10240
    ds_read_b64_tr_b16 v[78:79], v103 offset:11264
    s_waitcnt lgkmcnt(8)
    ds_read_b32 v111, v96 offset:592
    v_mfma_f32_16x16x32_bf16 v[20:23], v[60:63], v[40:43], v[20:23]
    v_mfma_f32_16x16x32_bf16 v[24:27], v[40:43], v[64:67], v[24:27]
    v_mfma_f32_16x16x32_bf16 v[16:19], v[56:59], v[40:43], v[16:19]
    v_mfma_f32_16x16x32_bf16 v[32:35], v[60:63], v[44:47], v[32:35]
    v_mfma_f32_16x16x32_bf16 v[36:39], v[44:47], v[64:67], v[36:39]
    v_mfma_f32_16x16x32_bf16 v[28:31], v[56:59], v[44:47], v[28:31]
    v_add_u32 v101, 114688, v98
    v_add_u32 v102, 114688, v99
    v_add_u32 v103, 114688, v100
    s_waitcnt lgkmcnt(0)
    s_mov_b64 exec, 1
    ds_add_u32 v96, v97 offset:656
    s_mov_b64 exec, -1
    v_readfirstlane_b32 s54, v111
    s_cmp_ge_u32 s54, 4
    s_cbranch_scc1 L_lok_13
L_lc_12:
    ds_read_b32 v111, v96 offset:592
    s_waitcnt lgkmcnt(0)
    v_readfirstlane_b32 s54, v111
    s_cmp_lt_u32 s54, 4
    s_cbranch_scc1 L_lc_12
L_lok_13:
    ds_read_b128 v[40:43], v101
    ds_read_b128 v[44:47], v102
    ds_read_b64_tr_b16 v[56:57], v103 offset:0
    ds_read_b64_tr_b16 v[58:59], v103 offset:1024
    ds_read_b64_tr_b16 v[60:61], v103 offset:4096
    ds_read_b64_tr_b16 v[62:63], v103 offset:5120
    ds_read_b64_tr_b16 v[64:65], v103 offset:8192
    ds_read_b64_tr_b16 v[66:67], v103 offset:9216
    v_xor_b32 v8, 64, v101
    v_xor_b32 v9, 64, v102
    v_mfma_f32_16x16x32_bf16 v[20:23], v[72:75], v[48:51], v[20:23]
    v_mfma_f32_16x16x32_bf16 v[24:27], v[48:51], v[76:79], v[24:27]
    v_mfma_f32_16x16x32_bf16 v[16:19], v[68:71], v[48:51], v[16:19]
    v_mfma_f32_16x16x32_bf16 v[32:35], v[72:75], v[52:55], v[32:35]
    v_mfma_f32_16x16x32_bf16 v[36:39], v[52:55], v[76:79], v[36:39]
    v_mfma_f32_16x16x32_bf16 v[28:31], v[68:71], v[52:55], v[28:31]
    ds_read_b128 v[48:51], v8
    ds_read_b128 v[52:55], v9
    ds_read_b64_tr_b16 v[68:69], v103 offset:2048
    ds_read_b64_tr_b16 v[70:71], v103 offset:3072
    ds_read_b64_tr_b16 v[72:73], v103 offset:6144
    ds_read_b64_tr_b16 v[74:75], v103 offset:7168
    ds_read_b64_tr_b16 v[76:77], v103 offset:10240
    ds_read_b64_tr_b16 v[78:79], v103 offset:11264
    s_waitcnt lgkmcnt(8)
    ds_read_b32 v111, v96 offset:596
    v_mfma_f32_16x16x32_bf16 v[20:23], v[60:63], v[40:43], v[20:23]
    v_mfma_f32_16x16x32_bf16 v[24:27], v[40:43], v[64:67], v[24:27]
    v_mfma_f32_16x16x32_bf16 v[16:19], v[56:59], v[40:43], v[16:19]
    v_mfma_f32_16x16x32_bf16 v[32:35], v[60:63], v[44:47], v[32:35]
    v_mfma_f32_16x16x32_bf16 v[36:39], v[44:47], v[64:67], v[36:39]
    v_mfma_f32_16x16x32_bf16 v[28:31], v[56:59], v[44:47], v[28:31]
    v_add_u32 v101, 0, v98
    v_add_u32 v102, 0, v99
    v_add_u32 v103, 0, v100
    s_waitcnt lgkmcnt(0)
    s_mov_b64 exec, 1
    ds_add_u32 v96, v97 offset:660
    s_mov_b64 exec, -1
    v_readfirstlane_b32 s54, v111
    s_cmp_ge_u32 s54, 4
    s_cbranch_scc1 L_lok_15
L_lc_14:
    ds_read_b32 v111, v96 offset:596
    s_waitcnt lgkmcnt(0)
    v_readfirstlane_b32 s54, v111
    s_cmp_lt_u32 s54, 4
    s_cbranch_scc1 L_lc_14
L_lok_15:
    ds_read_b128 v[40:43], v101
    ds_read_b128 v[44:47], v102
    ds_read_b64_tr_b16 v[56:57], v103 offset:0
    ds_read_b64_tr_b16 v[58:59], v103 offset:1024
    ds_read_b64_tr_b16 v[60:61], v103 offset:4096
    ds_read_b64_tr_b16 v[62:63], v103 offset:5120
    ds_read_b64_tr_b16 v[64:65], v103 offset:8192
    ds_read_b64_tr_b16 v[66:67], v103 offset:9216
    v_xor_b32 v8, 64, v101
    v_xor_b32 v9, 64, v102
    v_mfma_f32_16x16x32_bf16 v[20:23], v[72:75], v[48:51], v[20:23]
    v_mfma_f32_16x16x32_bf16 v[24:27], v[48:51], v[76:79], v[24:27]
    v_mfma_f32_16x16x32_bf16 v[16:19], v[68:71], v[48:51], v[16:19]
    v_mfma_f32_16x16x32_bf16 v[32:35], v[72:75], v[52:55], v[32:35]
    v_mfma_f32_16x16x32_bf16 v[36:39], v[52:55], v[76:79], v[36:39]
    v_mfma_f32_16x16x32_bf16 v[28:31], v[68:71], v[52:55], v[28:31]
    ds_read_b128 v[48:51], v8
    ds_read_b128 v[52:55], v9
    ds_read_b64_tr_b16 v[68:69], v103 offset:2048
    ds_read_b64_tr_b16 v[70:71], v103 offset:3072
    ds_read_b64_tr_b16 v[72:73], v103 offset:6144
    ds_read_b64_tr_b16 v[74:75], v103 offset:7168
    ds_read_b64_tr_b16 v[76:77], v103 offset:10240
    ds_read_b64_tr_b16 v[78:79], v103 offset:11264
    s_waitcnt lgkmcnt(8)
    ds_read_b32 v111, v96 offset:600
    v_mfma_f32_16x16x32_bf16 v[20:23], v[60:63], v[40:43], v[20:23]
    v_mfma_f32_16x16x32_bf16 v[24:27], v[40:43], v[64:67], v[24:27]
    v_mfma_f32_16x16x32_bf16 v[16:19], v[56:59], v[40:43], v[16:19]
    v_mfma_f32_16x16x32_bf16 v[32:35], v[60:63], v[44:47], v[32:35]
    v_mfma_f32_16x16x32_bf16 v[36:39], v[44:47], v[64:67], v[36:39]
    v_mfma_f32_16x16x32_bf16 v[28:31], v[56:59], v[44:47], v[28:31]
    v_add_u32 v101, 28672, v98
    v_add_u32 v102, 28672, v99
    v_add_u32 v103, 28672, v100
    s_waitcnt lgkmcnt(0)
    v_readfirstlane_b32 s54, v111
    s_cmp_ge_u32 s54, 4
    s_cbranch_scc1 L_lok_17
L_lc_16:
    ds_read_b32 v111, v96 offset:600
    s_waitcnt lgkmcnt(0)
    v_readfirstlane_b32 s54, v111
    s_cmp_lt_u32 s54, 4
    s_cbranch_scc1 L_lc_16
L_lok_17:
    s_waitcnt vmcnt(0)
    s_lshl_b32 s58, s11, 7
    s_lshl_b32 s54, s14, 5
    s_add_u32 s58, s58, s54
    s_lshl_b32 s58, s58, 4
    s_add_u32 s58, s58, 9306112
    s_lshl_b32 s59, s15, 12
    s_add_u32 s59, s59, 9371648
    v_and_b32 v164, 31, v1
    v_lshlrev_b32 v164, 4, v164
    buffer_load_dwordx4 v[112:115], v164, s[24:27], s58 offen sc1
    buffer_load_dwordx4 v[116:119], v3, s[24:27], s59 offen offset:0 sc1
    buffer_load_dwordx4 v[120:123], v3, s[24:27], s59 offen offset:1024 sc1
    buffer_load_dwordx4 v[124:127], v3, s[24:27], s59 offen offset:2048 sc1
    buffer_load_dwordx4 v[128:131], v3, s[24:27], s59 offen offset:3072 sc1
    ds_read_b128 v[40:43], v101
    ds_read_b128 v[44:47], v102
    ds_read_b64_tr_b16 v[56:57], v103 offset:0
    ds_read_b64_tr_b16 v[58:59], v103 offset:1024
    ds_read_b64_tr_b16 v[60:61], v103 offset:4096
    ds_read_b64_tr_b16 v[62:63], v103 offset:5120
    ds_read_b64_tr_b16 v[64:65], v103 offset:8192
    ds_read_b64_tr_b16 v[66:67], v103 offset:9216
    v_xor_b32 v8, 64, v101
    v_xor_b32 v9, 64, v102
    v_mfma_f32_16x16x32_bf16 v[20:23], v[72:75], v[48:51], v[20:23]
    v_mfma_f32_16x16x32_bf16 v[24:27], v[48:51], v[76:79], v[24:27]
    v_mfma_f32_16x16x32_bf16 v[16:19], v[68:71], v[48:51], v[16:19]
    v_mfma_f32_16x16x32_bf16 v[32:35], v[72:75], v[52:55], v[32:35]
    v_mfma_f32_16x16x32_bf16 v[36:39], v[52:55], v[76:79], v[36:39]
    v_mfma_f32_16x16x32_bf16 v[28:31], v[68:71], v[52:55], v[28:31]
    ds_read_b128 v[48:51], v8
    ds_read_b128 v[52:55], v9
    ds_read_b64_tr_b16 v[68:69], v103 offset:2048
    ds_read_b64_tr_b16 v[70:71], v103 offset:3072
    ds_read_b64_tr_b16 v[72:73], v103 offset:6144
    ds_read_b64_tr_b16 v[74:75], v103 offset:7168
    ds_read_b64_tr_b16 v[76:77], v103 offset:10240
    ds_read_b64_tr_b16 v[78:79], v103 offset:11264
    s_waitcnt lgkmcnt(8)
    ds_read_b32 v111, v96 offset:604
    v_mfma_f32_16x16x32_bf16 v[20:23], v[60:63], v[40:43], v[20:23]
    v_mfma_f32_16x16x32_bf16 v[24:27], v[40:43], v[64:67], v[24:27]
    v_mfma_f32_16x16x32_bf16 v[16:19], v[56:59], v[40:43], v[16:19]
    v_mfma_f32_16x16x32_bf16 v[32:35], v[60:63], v[44:47], v[32:35]
    v_mfma_f32_16x16x32_bf16 v[36:39], v[44:47], v[64:67], v[36:39]
    v_mfma_f32_16x16x32_bf16 v[28:31], v[56:59], v[44:47], v[28:31]
    v_add_u32 v101, 57344, v98
    v_add_u32 v102, 57344, v99
    v_add_u32 v103, 57344, v100
    s_waitcnt lgkmcnt(0)
    v_readfirstlane_b32 s54, v111
    s_cmp_ge_u32 s54, 4
    s_cbranch_scc1 L_lok_19
L_lc_18:
    ds_read_b32 v111, v96 offset:604
    s_waitcnt lgkmcnt(0)
    v_readfirstlane_b32 s54, v111
    s_cmp_lt_u32 s54, 4
    s_cbranch_scc1 L_lc_18
L_lok_19:
    s_branch L_shc_22
L_sh_20:
    s_cmp_eq_u32 s53, 0
    s_cbranch_scc1 L_sho_21
    s_sub_u32 s53, s53, 1
    buffer_load_dwordx4 v[112:115], v164, s[24:27], s58 offen sc1
    buffer_load_dwordx4 v[116:119], v3, s[24:27], s59 offen offset:0 sc1
    buffer_load_dwordx4 v[120:123], v3, s[24:27], s59 offen offset:1024 sc1
    buffer_load_dwordx4 v[124:127], v3, s[24:27], s59 offen offset:2048 sc1
    buffer_load_dwordx4 v[128:131], v3, s[24:27], s59 offen offset:3072 sc1
L_shc_22:
    s_waitcnt vmcnt(0)
    v_min3_u32 v6, v115, v119, v123
    v_min3_u32 v6, v127, v131, v6
    v_max3_u32 v7, v115, v119, v123
    v_max3_u32 v7, v127, v131, v7
    v_cmp_eq_u32 vcc, s52, v6
    v_cmp_eq_u32 s[54:55], s52, v7
    s_and_b64 vcc, vcc, s[54:55]
    s_cmp_eq_u64 vcc, exec
    s_cbranch_scc0 L_sh_20
L_sho_21:
    v_add_f32 v116, v116, v120
    v_add_f32 v124, v124, v128
    v_add_f32 v116, v116, v124
    v_add_f32 v117, v117, v121
    v_add_f32 v125, v125, v129
    v_add_f32 v117, v117, v125
    v_add_f32 v118, v118, v122
    v_add_f32 v126, v126, v130
    v_add_f32 v118, v118, v126
    v_mov_b32 v6, v116
    s_nop 1
    v_permlane16_swap_b32 v116, v6
    v_add_f32 v116, v116, v6
    v_mov_b32 v6, v116
    s_nop 1
    v_permlane32_swap_b32 v116, v6
    v_add_f32 v116, v116, v6
    v_mov_b32 v6, v117
    s_nop 1
    v_permlane16_swap_b32 v117, v6
    v_add_f32 v117, v117, v6
    v_mov_b32 v6, v117
    s_nop 1
    v_permlane32_swap_b32 v117, v6
    v_add_f32 v117, v117, v6
    v_mov_b32 v6, v118
    s_nop 1
    v_permlane16_swap_b32 v118, v6
    v_add_f32 v118, v118, v6
    v_mov_b32 v6, v118
    s_nop 1
    v_permlane32_swap_b32 v118, v6
    v_add_f32 v118, v118, v6
    s_lshl_b32 s54, s12, 9
    s_add_u32 s54, s54, 143360
    v_lshrrev_b32 v6, 1, v164
    v_add_u32 v6, s54, v6
    ds_write_b64 v6, v[112:113]
    v_lshlrev_b32 v7, 3, v4
    v_add_u32 v7, s54, v7
    ds_write_b64 v7, v[116:117] offset:256
    v_mov_b32 v80, v118
    s_lshl_b32 s55, s13, 7
    v_add_u32 v7, s55, v7
    v_xor_b32 v6, 0x80, v7
    v_lshlrev_b32 v165, 5, v5
    v_add_u32 v165, s54, v165
    v_add_u32 v166, s55, v165
    v_xor_b32 v164, 0x80, v166
    s_waitcnt lgkmcnt(0)
    ds_read_b64 v[132:133], v7
    ds_read_b64 v[134:135], v6
    ds_read_b128 v[112:115], v166
    ds_read_b128 v[116:119], v166 offset:16
    ds_read_b128 v[120:123], v164
    ds_read_b128 v[124:127], v164 offset:16
    ds_read_b128 v[84:87], v165 offset:256
    ds_read_b128 v[88:91], v165 offset:272
    ds_read_b64 v[128:129], v96 offset:656
    ds_read_b128 v[40:43], v101
    ds_read_b128 v[44:47], v102
    ds_read_b64_tr_b16 v[56:57], v103 offset:0
    ds_read_b64_tr_b16 v[58:59], v103 offset:1024
    ds_read_b64_tr_b16 v[60:61], v103 offset:4096
    ds_read_b64_tr_b16 v[62:63], v103 offset:5120
    ds_read_b64_tr_b16 v[64:65], v103 offset:8192
    ds_read_b64_tr_b16 v[66:67], v103 offset:9216
    v_xor_b32 v8, 64, v101
    v_xor_b32 v9, 64, v102
    v_mfma_f32_16x16x32_bf16 v[20:23], v[72:75], v[48:51], v[20:23]
    v_mfma_f32_16x16x32_bf16 v[24:27], v[48:51], v[76:79], v[24:27]
    v_mfma_f32_16x16x32_bf16 v[16:19], v[68:71], v[48:51], v[16:19]
    v_mfma_f32_16x16x32_bf16 v[32:35], v[72:75], v[52:55], v[32:35]
    v_mfma_f32_16x16x32_bf16 v[36:39], v[52:55], v[76:79], v[36:39]
    v_mfma_f32_16x16x32_bf16 v[28:31], v[68:71], v[52:55], v[28:31]
    ds_read_b128 v[48:51], v8
    ds_read_b128 v[52:55], v9
    ds_read_b64_tr_b16 v[68:69], v103 offset:2048
    ds_read_b64_tr_b16 v[70:71], v103 offset:3072
    ds_read_b64_tr_b16 v[72:73], v103 offset:6144
    ds_read_b64_tr_b16 v[74:75], v103 offset:7168
    ds_read_b64_tr_b16 v[76:77], v103 offset:10240
    ds_read_b64_tr_b16 v[78:79], v103 offset:11264
    s_waitcnt lgkmcnt(8)
    v_mfma_f32_16x16x32_bf16 v[20:23], v[60:63], v[40:43], v[20:23]
    v_mfma_f32_16x16x32_bf16 v[24:27], v[40:43], v[64:67], v[24:27]
    v_mfma_f32_16x16x32_bf16 v[16:19], v[56:59], v[40:43], v[16:19]
    v_mfma_f32_16x16x32_bf16 v[32:35], v[60:63], v[44:47], v[32:35]
    v_mfma_f32_16x16x32_bf16 v[36:39], v[44:47], v[64:67], v[36:39]
    v_mfma_f32_16x16x32_bf16 v[28:31], v[56:59], v[44:47], v[28:31]
    s_waitcnt vmcnt(0) lgkmcnt(0)
    v_mfma_f32_16x16x32_bf16 v[20:23], v[72:75], v[48:51], v[20:23]
    v_mfma_f32_16x16x32_bf16 v[24:27], v[48:51], v[76:79], v[24:27]
    v_mfma_f32_16x16x32_bf16 v[16:19], v[68:71], v[48:51], v[16:19]
    v_mfma_f32_16x16x32_bf16 v[32:35], v[72:75], v[52:55], v[32:35]
    v_mfma_f32_16x16x32_bf16 v[36:39], v[52:55], v[76:79], v[36:39]
    v_mfma_f32_16x16x32_bf16 v[28:31], v[68:71], v[52:55], v[28:31]
    v_min_u32 v128, v128, v129
    s_nop 0
    v_readfirstlane_b32 s54, v128
    s_cmp_ge_u32 s54, 8
    s_cbranch_scc1 L_okc_23
    v_mov_b32 v6, 163472
L_lw_24:
    s_sleep 0
    ds_read_b32 v7, v6
    s_waitcnt lgkmcnt(0)
    v_readfirstlane_b32 s54, v7
    s_cmp_lt_u32 s54, 8
    s_cbranch_scc1 L_lw_24
    v_mov_b32 v6, 163476
L_lw_25:
    s_sleep 0
    ds_read_b32 v7, v6
    s_waitcnt lgkmcnt(0)
    v_readfirstlane_b32 s54, v7
    s_cmp_lt_u32 s54, 8
    s_cbranch_scc1 L_lw_25
L_okc_23:
    v_fma_f32 v68, -v132, v85, v20
    v_mul_f32 v68, v133, v68
    v_fma_f32 v69, -v132, v87, v21
    v_mul_f32 v69, v133, v69
    v_fma_f32 v70, -v132, v89, v22
    v_mul_f32 v70, v133, v70
    v_fma_f32 v71, -v132, v91, v23
    v_mul_f32 v71, v133, v71
    v_cvt_pk_bf16_f32 v72, v68, v69
    v_cvt_pk_bf16_f32 v73, v70, v71
    ds_write_b64 v106, v[72:73]
    v_mul_f32 v64, v68, v68
    v_fmac_f32 v64, v69, v69
    v_fmac_f32 v64, v70, v70
    v_fmac_f32 v64, v71, v71
    v_fma_f32 v68, -v112, v80, v24
    v_mul_f32 v68, v113, v68
    v_fma_f32 v69, -v114, v80, v25
    v_mul_f32 v69, v115, v69
    v_fma_f32 v70, -v116, v80, v26
    v_mul_f32 v70, v117, v70
    v_fma_f32 v71, -v118, v80, v27
    v_mul_f32 v71, v119, v71
    v_cvt_pk_bf16_f32 v74, v68, v69
    v_cvt_pk_bf16_f32 v75, v70, v71
    ds_write_b64 v105, v[74:75] offset:1024
    v_max3_f32 v15, |v68|, |v69|, v15
    v_max3_f32 v15, |v70|, |v71|, v15
    v_fma_f32 v68, -v134, v85, v32
    v_mul_f32 v68, v135, v68
    v_fma_f32 v69, -v134, v87, v33
    v_mul_f32 v69, v135, v69
    v_fma_f32 v70, -v134, v89, v34
    v_mul_f32 v70, v135, v70
    v_fma_f32 v71, -v134, v91, v35
    v_mul_f32 v71, v135, v71
    v_cvt_pk_bf16_f32 v72, v68, v69
    v_cvt_pk_bf16_f32 v73, v70, v71
    ds_write_b64 v108, v[72:73]
    v_mul_f32 v65, v68, v68
    v_fmac_f32 v65, v69, v69
    v_fmac_f32 v65, v70, v70
    v_fmac_f32 v65, v71, v71
    v_fma_f32 v68, -v120, v80, v36
    v_mul_f32 v68, v121, v68
    v_fma_f32 v69, -v122, v80, v37
    v_mul_f32 v69, v123, v69
    v_fma_f32 v70, -v124, v80, v38
    v_mul_f32 v70, v125, v70
    v_fma_f32 v71, -v126, v80, v39
    v_mul_f32 v71, v127, v71
    v_cvt_pk_bf16_f32 v74, v68, v69
    v_cvt_pk_bf16_f32 v75, v70, v71
    ds_write_b64 v109, v[74:75] offset:1024
    v_max3_f32 v15, |v68|, |v69|, v15
    v_max3_f32 v15, |v70|, |v71|, v15
    s_waitcnt lgkmcnt(0)
    ds_read_b128 v[136:139], v107
    ds_read_b128 v[76:79], v107 offset:1024
    s_mov_b64 exec, s[60:61]
    ds_read_b128 v[144:147], v11
    ds_read_b128 v[148:151], v11 offset:512
    s_mov_b64 exec, -1
    v_mov_b32 v66, 0
    v_mul_f32 v6, 0x3eb8aa3b, v133
    v_fma_f32 v68, -v132, v84, v16
    v_mul_f32 v68, v6, v68
    v_fma_f32 v69, -v132, v86, v17
    v_mul_f32 v69, v6, v69
    v_fma_f32 v70, -v132, v88, v18
    v_mul_f32 v70, v6, v70
    v_fma_f32 v71, -v132, v90, v19
    v_mul_f32 v71, v6, v71
    s_waitcnt lgkmcnt(0)
    buffer_store_dwordx4 v[136:139], v3, s[24:27], s33 offen sc1
    buffer_store_dwordx4 v[76:79], v3, s[24:27], s34 offen sc1
    v_cvt_pk_bf16_f32 v72, v68, v69
    v_cvt_pk_bf16_f32 v73, v70, v71
    ds_write_b64 v104, v[72:73]
    v_mul_f32 v67, v68, v68
    v_fmac_f32 v67, v69, v69
    v_fmac_f32 v67, v70, v70
    v_fmac_f32 v67, v71, v71
    v_mov_b32 v6, v67
    s_nop 1
    v_permlane16_swap_b32 v67, v6
    v_add_f32 v67, v67, v6
    v_mov_b32 v6, v67
    s_nop 1
    v_permlane32_swap_b32 v67, v6
    v_add_f32 v67, v67, v6
    v_max_f32 v66, v66, v67
    v_mul_f32 v6, 0x3eb8aa3b, v135
    v_fma_f32 v68, -v134, v84, v28
    v_mul_f32 v68, v6, v68
    v_fma_f32 v69, -v134, v86, v29
    v_mul_f32 v69, v6, v69
    v_fma_f32 v70, -v134, v88, v30
    v_mul_f32 v70, v6, v70
    v_fma_f32 v71, -v134, v90, v31
    v_mul_f32 v71, v6, v71
    v_cvt_pk_bf16_f32 v72, v68, v69
    v_cvt_pk_bf16_f32 v73, v70, v71
    ds_write_b64 v110, v[72:73]
    v_mul_f32 v67, v68, v68
    v_fmac_f32 v67, v69, v69
    v_fmac_f32 v67, v70, v70
    v_fmac_f32 v67, v71, v71
    v_mov_b32 v6, v67
    s_nop 1
    v_permlane16_swap_b32 v67, v6
    v_add_f32 v67, v67, v6
    v_mov_b32 v6, v67
    s_nop 1
    v_permlane32_swap_b32 v67, v6
    v_add_f32 v67, v67, v6
    v_max_f32 v66, v66, v67
    s_nop 1
    v_max_f32_dpp v66, v66, v66 row_ror:1 row_mask:0xf bank_mask:0xf
    s_nop 1
    v_max_f32_dpp v66, v66, v66 row_ror:2 row_mask:0xf bank_mask:0xf
    s_nop 1
    v_max_f32_dpp v66, v66, v66 row_ror:4 row_mask:0xf bank_mask:0xf
    s_nop 1
    v_max_f32_dpp v66, v66, v66 row_ror:8 row_mask:0xf bank_mask:0xf
    s_lshl_b32 s54, s12, 2
    s_add_u32 s54, s54, 114688
    v_mov_b32 v6, s54
    ds_write_b32 v6, v66
    s_waitcnt lgkmcnt(0)
    s_barrier
    v_mov_b32 v7, v64
    v_mov_b32 v8, v65
    ds_read_b32 v9, v14
    ds_read_b128 v[56:59], v10 offset:0
    ds_read_b128 v[60:63], v10 offset:1024
    ds_read_b128 v[64:67], v10 offset:2048
    ds_read_b128 v[68:71], v10 offset:3072
    v_mov_b32 v6, v7
    s_nop 1
    v_permlane16_swap_b32 v7, v6
    v_add_f32 v7, v7, v6
    v_mov_b32 v6, v7
    s_nop 1
    v_permlane32_swap_b32 v7, v6
    v_add_f32 v7, v7, v6
    v_mov_b32 v6, v8
    s_nop 1
    v_permlane16_swap_b32 v8, v6
    v_add_f32 v8, v8, v6
    v_mov_b32 v6, v8
    s_nop 1
    v_permlane32_swap_b32 v8, v6
    v_add_f32 v8, v8, v6
    v_max_f32 v14, v7, v8
    v_mov_b32 v6, 0x53800000
    v_cmp_nge_f32 vcc, v6, v15
    v_mov_b32 v6, 0x7f800000
    s_nop 0
    v_cndmask_b32 v14, v14, v6, vcc
    s_nop 1
    v_max_f32_dpp v14, v14, v14 row_ror:1 row_mask:0xf bank_mask:0xf
    s_nop 1
    v_max_f32_dpp v14, v14, v14 row_ror:2 row_mask:0xf bank_mask:0xf
    s_nop 1
    v_max_f32_dpp v14, v14, v14 row_ror:4 row_mask:0xf bank_mask:0xf
    s_nop 1
    v_max_f32_dpp v14, v14, v14 row_ror:8 row_mask:0xf bank_mask:0xf
    v_mov_b32 v6, v14
    s_nop 1
    v_permlane16_swap_b32 v14, v6
    v_max_f32 v14, v14, v6
    v_mov_b32 v6, v14
    s_nop 1
    v_permlane32_swap_b32 v14, v6
    v_max_f32 v14, v14, v6
    s_waitcnt lgkmcnt(0)
    s_barrier
    s_mov_b32 s3, 0x07060302
    v_mfma_f32_32x32x16_bf16 v[24:39], v[136:139], v[56:59], 0
    s_nop 1
    v_max_f32_dpp v9, v9, v9 row_ror:1 row_mask:0xf bank_mask:0xf
    s_nop 1
    v_max_f32_dpp v9, v9, v9 row_ror:2 row_mask:0xf bank_mask:0xf
    s_nop 1
    v_max_f32_dpp v9, v9, v9 row_ror:4 row_mask:0xf bank_mask:0xf
    s_nop 1
    v_max_f32_dpp v9, v9, v9 row_ror:8 row_mask:0xf bank_mask:0xf
    v_mov_b32 v164, s52
    v_mov_b32 v165, v14
    v_mov_b32 v166, v14
    v_mov_b32 v167, s52
    s_lshl_b32 s55, s11, 4
    s_add_u32 s54, s63, s55
    v_mov_b32 v6, 0
    s_waitcnt vmcnt(0)
    s_mov_b64 exec, 1
    buffer_store_dwordx4 v[164:167], v6, s[24:27], s54 offen sc1
    s_mov_b64 exec, -1
    v_mul_f32 v6, v9, v14
    v_cmp_ge_f32 vcc, 0x45610000, v6
    s_cmp_eq_u64 vcc, exec
    s_cbranch_scc0 L_slow0
    v_mfma_f32_32x32x16_bf16 v[40:55], v[136:139], v[60:63], 0
    v_exp_f32 v24, v24
    v_exp_f32 v25, v25
    v_exp_f32 v26, v26
    v_exp_f32 v27, v27
    v_cvt_pk_bf16_f32 v16, v24, v25
    v_exp_f32 v28, v28
    v_exp_f32 v29, v29
    v_cvt_pk_bf16_f32 v17, v26, v27
    v_exp_f32 v30, v30
    v_exp_f32 v31, v31
    v_cvt_pk_bf16_f32 v18, v28, v29
    v_exp_f32 v32, v32
    v_cvt_pk_bf16_f32 v19, v30, v31
    v_exp_f32 v33, v33
    v_exp_f32 v34, v34
    v_mfma_f32_32x32x16_bf16 v[72:87], v[144:147], v[16:19], 0
    v_exp_f32 v35, v35
    v_cvt_pk_bf16_f32 v20, v32, v33
    v_exp_f32 v36, v36
    v_exp_f32 v37, v37
    v_cvt_pk_bf16_f32 v21, v34, v35
    v_exp_f32 v38, v38
    v_exp_f32 v39, v39
    v_cvt_pk_bf16_f32 v22, v36, v37
    s_nop 0
    v_cvt_pk_bf16_f32 v23, v38, v39
    v_mfma_f32_32x32x16_bf16 v[24:39], v[136:139], v[64:67], 0
    v_exp_f32 v40, v40
    v_exp_f32 v41, v41
    v_exp_f32 v42, v42
    v_exp_f32 v43, v43
    v_cvt_pk_bf16_f32 v16, v40, v41
    v_mfma_f32_32x32x16_bf16 v[72:87], v[148:151], v[20:23], v[72:87]
    v_exp_f32 v44, v44
    v_exp_f32 v45, v45
    v_cvt_pk_bf16_f32 v17, v42, v43
    v_exp_f32 v46, v46
    v_exp_f32 v47, v47
    v_cvt_pk_bf16_f32 v18, v44, v45
    v_exp_f32 v48, v48
    v_cvt_pk_bf16_f32 v19, v46, v47
    v_exp_f32 v49, v49
    v_exp_f32 v50, v50
    v_mfma_f32_32x32x16_bf16 v[88:103], v[144:147], v[16:19], 0
    v_exp_f32 v51, v51
    v_cvt_pk_bf16_f32 v20, v48, v49
    v_exp_f32 v52, v52
    v_exp_f32 v53, v53
    v_cvt_pk_bf16_f32 v21, v50, v51
    v_exp_f32 v54, v54
    v_exp_f32 v55, v55
    v_cvt_pk_bf16_f32 v22, v52, v53
    s_nop 0
    v_cvt_pk_bf16_f32 v23, v54, v55
    v_mfma_f32_32x32x16_bf16 v[40:55], v[136:139], v[68:71], 0
    v_exp_f32 v24, v24
    v_exp_f32 v25, v25
    v_exp_f32 v26, v26
    v_exp_f32 v27, v27
    v_cvt_pk_bf16_f32 v16, v24, v25
    v_mfma_f32_32x32x16_bf16 v[88:103], v[148:151], v[20:23], v[88:103]
    v_exp_f32 v28, v28
    v_exp_f32 v29, v29
    v_cvt_pk_bf16_f32 v17, v26, v27
    v_exp_f32 v30, v30
    v_exp_f32 v31, v31
    v_cvt_pk_bf16_f32 v18, v28, v29
    v_exp_f32 v32, v32
    v_cvt_pk_bf16_f32 v19, v30, v31
    v_exp_f32 v33, v33
    v_exp_f32 v34, v34
    v_mfma_f32_32x32x16_bf16 v[104:119], v[144:147], v[16:19], 0
    v_exp_f32 v35, v35
    v_cvt_pk_bf16_f32 v20, v32, v33
    v_exp_f32 v36, v36
    v_exp_f32 v37, v37
    v_cvt_pk_bf16_f32 v21, v34, v35
    v_exp_f32 v38, v38
    v_exp_f32 v39, v39
    v_cvt_pk_bf16_f32 v22, v36, v37
    v_lshlrev_b32 v10, 4, v4
    buffer_load_dwordx4 v[164:167], v10, s[24:27], s63 offen sc1
    v_cvt_pk_bf16_f32 v23, v38, v39
    v_exp_f32 v40, v40
    v_exp_f32 v41, v41
    v_exp_f32 v42, v42
    v_exp_f32 v43, v43
    v_cvt_pk_bf16_f32 v16, v40, v41
    v_mfma_f32_32x32x16_bf16 v[104:119], v[148:151], v[20:23], v[104:119]
    v_exp_f32 v44, v44
    v_exp_f32 v45, v45
    v_cvt_pk_bf16_f32 v17, v42, v43
    v_exp_f32 v46, v46
    v_exp_f32 v47, v47
    v_cvt_pk_bf16_f32 v18, v44, v45
    v_exp_f32 v48, v48
    v_cvt_pk_bf16_f32 v19, v46, v47
    v_exp_f32 v49, v49
    v_exp_f32 v50, v50
    v_mfma_f32_32x32x16_bf16 v[120:135], v[144:147], v[16:19], 0
    v_exp_f32 v51, v51
    v_cvt_pk_bf16_f32 v20, v48, v49
    v_exp_f32 v52, v52
    v_exp_f32 v53, v53
    v_cvt_pk_bf16_f32 v21, v50, v51
    v_exp_f32 v54, v54
    v_exp_f32 v55, v55
    v_cvt_pk_bf16_f32 v22, v52, v53
    s_mov_b32 s59, 0
    s_waitcnt vmcnt(0)
    v_cmp_eq_u32 vcc, s52, v164
    v_cmp_eq_u32 s[54:55], s52, v167
    s_and_b64 vcc, vcc, s[54:55]
    s_cmp_eq_u64 vcc, exec
    s_cbranch_scc0 L_nel_26
    v_mul_f32 v6, v9, v165
    v_cmp_ge_f32 vcc, 0x45610000, v6
    s_cmp_eq_u64 vcc, exec
    s_cbranch_scc0 L_nel_26
    s_add_u32 s58, s11, 1
    s_and_b32 s58, s58, 15
    s_lshl_b32 s58, s58, 12
    s_add_u32 s55, s56, s58
    buffer_load_dwordx4 v[140:143], v3, s[24:27], s55 offen sc1
    s_add_u32 s55, s57, s58
    s_mov_b64 exec, s[60:61]
    buffer_load_dwordx4 v[152:155], v12, s[24:27], s55 offen sc1
    buffer_load_dwordx4 v[156:159], v12, s[24:27], s55 offen offset:512 sc1
    s_mov_b64 exec, -1
    s_add_u32 s58, s11, 2
    s_and_b32 s58, s58, 15
    s_lshl_b32 s58, s58, 12
    s_add_u32 s55, s56, s58
    buffer_load_dwordx4 v[136:139], v3, s[24:27], s55 offen sc1
    s_mov_b32 s59, 1
L_nel_26:
    v_cvt_pk_bf16_f32 v23, v54, v55
    s_nop 1
    v_mfma_f32_32x32x16_bf16 v[120:135], v[148:151], v[20:23], v[120:135]
    v_mov_b32 v20, 0
    v_mov_b32 v21, 0
    v_mov_b32 v22, 0
    v_mov_b32 v23, 0
    s_cmp_eq_u32 s59, 1
    s_cbranch_scc1 L_go
    v_lshlrev_b32 v10, 4, v4
L_pkv_27:
    s_cmp_eq_u32 s53, 0
    s_cbranch_scc1 L_pkvo_28
    s_sub_u32 s53, s53, 1
    buffer_load_dwordx4 v[164:167], v10, s[24:27], s63 offen sc1
L_pkvc_29:
    s_waitcnt vmcnt(0)
    v_cmp_eq_u32 vcc, s52, v164
    v_cmp_eq_u32 s[54:55], s52, v167
    s_and_b64 vcc, vcc, s[54:55]
    s_cmp_eq_u64 vcc, exec
    s_cbranch_scc0 L_pkv_27
L_pkvo_28:
    v_mul_f32 v6, v9, v165
    v_cmp_ge_f32 vcc, 0x45610000, v6
    s_cmp_eq_u64 vcc, exec
    s_cbranch_scc0 L_slow1
    s_add_u32 s58, s11, 1
    s_and_b32 s58, s58, 15
    s_lshl_b32 s58, s58, 12
    s_add_u32 s55, s56, s58
    buffer_load_dwordx4 v[140:143], v3, s[24:27], s55 offen sc1
    s_add_u32 s55, s57, s58
    s_mov_b64 exec, s[60:61]
    buffer_load_dwordx4 v[152:155], v12, s[24:27], s55 offen sc1
    buffer_load_dwordx4 v[156:159], v12, s[24:27], s55 offen offset:512 sc1
    s_mov_b64 exec, -1
    s_add_u32 s58, s11, 2
    s_and_b32 s58, s58, 15
    s_lshl_b32 s58, s58, 12
    s_add_u32 s55, s56, s58
    buffer_load_dwordx4 v[136:139], v3, s[24:27], s55 offen sc1
L_go:
    v_mov_b32 v6, 162856
    v_mov_b32 v7, 1
    s_mov_b64 exec, 1
    ds_add_u32 v6, v7
    s_mov_b64 exec, -1
    s_waitcnt vmcnt(3)
    v_mfma_f32_32x32x16_bf16 v[24:39], v[140:143], v[56:59], 0
    s_mov_b32 s59, 1
    s_nop 15
L_loopf:
    v_mfma_f32_32x32x16_bf16 v[40:55], v[140:143], v[60:63], 0
    v_exp_f32 v24, v24
    v_exp_f32 v25, v25
    v_exp_f32 v26, v26
    v_exp_f32 v27, v27
    v_cvt_pk_bf16_f32 v16, v24, v25
    v_mfma_f32_32x32x16_bf16 v[120:135], v[148:151], v[20:23], v[120:135]
    v_exp_f32 v28, v28
    v_exp_f32 v29, v29
    v_cvt_pk_bf16_f32 v17, v26, v27
    v_exp_f32 v30, v30
    v_exp_f32 v31, v31
    v_cvt_pk_bf16_f32 v18, v28, v29
    v_exp_f32 v32, v32
    v_cvt_pk_bf16_f32 v19, v30, v31
    v_exp_f32 v33, v33
    s_waitcnt vmcnt(1)
    v_exp_f32 v34, v34
    v_mfma_f32_32x32x16_bf16 v[72:87], v[152:155], v[16:19], v[72:87]
    v_exp_f32 v35, v35
    v_cvt_pk_bf16_f32 v20, v32, v33
    v_exp_f32 v36, v36
    v_exp_f32 v37, v37
    v_cvt_pk_bf16_f32 v21, v34, v35
    v_exp_f32 v38, v38
    v_exp_f32 v39, v39
    v_cvt_pk_bf16_f32 v22, v36, v37
    s_add_u32 s55, s57, s58
    s_mov_b64 exec, s[60:61]
    buffer_load_dwordx4 v[144:147], v12, s[24:27], s55 offen sc1
    buffer_load_dwordx4 v[148:151], v12, s[24:27], s55 offen offset:512 sc1
    s_mov_b64 exec, -1
    v_cvt_pk_bf16_f32 v23, v38, v39
    v_mfma_f32_32x32x16_bf16 v[24:39], v[140:143], v[64:67], 0
    v_exp_f32 v40, v40
    v_exp_f32 v41, v41
    v_exp_f32 v42, v42
    v_exp_f32 v43, v43
    v_cvt_pk_bf16_f32 v16, v40, v41
    v_mfma_f32_32x32x16_bf16 v[72:87], v[156:159], v[20:23], v[72:87]
    v_exp_f32 v44, v44
    v_exp_f32 v45, v45
    v_cvt_pk_bf16_f32 v17, v42, v43
    v_exp_f32 v46, v46
    v_exp_f32 v47, v47
    v_cvt_pk_bf16_f32 v18, v44, v45
    v_exp_f32 v48, v48
    v_cvt_pk_bf16_f32 v19, v46, v47
    v_exp_f32 v49, v49
    v_exp_f32 v50, v50
    v_mfma_f32_32x32x16_bf16 v[88:103], v[152:155], v[16:19], v[88:103]
    v_exp_f32 v51, v51
    v_cvt_pk_bf16_f32 v20, v48, v49
    v_exp_f32 v52, v52
    v_exp_f32 v53, v53
    v_cvt_pk_bf16_f32 v21, v50, v51
    v_exp_f32 v54, v54
    v_exp_f32 v55, v55
    v_cvt_pk_bf16_f32 v22, v52, v53
    s_nop 0
    v_cvt_pk_bf16_f32 v23, v54, v55
    v_mfma_f32_32x32x16_bf16 v[40:55], v[140:143], v[68:71], 0
    v_exp_f32 v24, v24
    v_exp_f32 v25, v25
    v_exp_f32 v26, v26
    v_exp_f32 v27, v27
    v_cvt_pk_bf16_f32 v16, v24, v25
    v_mfma_f32_32x32x16_bf16 v[88:103], v[156:159], v[20:23], v[88:103]
    v_exp_f32 v28, v28
    v_exp_f32 v29, v29
    v_cvt_pk_bf16_f32 v17, v26, v27
    v_exp_f32 v30, v30
    v_exp_f32 v31, v31
    v_cvt_pk_bf16_f32 v18, v28, v29
    v_exp_f32 v32, v32
    v_cvt_pk_bf16_f32 v19, v30, v31
    v_exp_f32 v33, v33
    v_exp_f32 v34, v34
    v_mfma_f32_32x32x16_bf16 v[104:119], v[152:155], v[16:19], v[104:119]
    v_exp_f32 v35, v35
    v_cvt_pk_bf16_f32 v20, v32, v33
    v_exp_f32 v36, v36
    v_exp_f32 v37, v37
    v_cvt_pk_bf16_f32 v21, v34, v35
    v_exp_f32 v38, v38
    v_exp_f32 v39, v39
    v_cvt_pk_bf16_f32 v22, v36, v37
    s_nop 0
    v_cvt_pk_bf16_f32 v23, v38, v39
    s_waitcnt vmcnt(2)
    v_mfma_f32_32x32x16_bf16 v[24:39], v[136:139], v[56:59], 0
    v_exp_f32 v40, v40
    v_exp_f32 v41, v41
    v_exp_f32 v42, v42
    v_exp_f32 v43, v43
    v_cvt_pk_bf16_f32 v16, v40, v41
    v_mfma_f32_32x32x16_bf16 v[104:119], v[156:159], v[20:23], v[104:119]
    v_exp_f32 v44, v44
    v_exp_f32 v45, v45
    v_cvt_pk_bf16_f32 v17, v42, v43
    v_exp_f32 v46, v46
    v_exp_f32 v47, v47
    v_cvt_pk_bf16_f32 v18, v44, v45
    v_exp_f32 v48, v48
    v_cvt_pk_bf16_f32 v19, v46, v47
    v_exp_f32 v49, v49
    v_exp_f32 v50, v50
    v_mfma_f32_32x32x16_bf16 v[120:135], v[152:155], v[16:19], v[120:135]
    v_exp_f32 v51, v51
    v_cvt_pk_bf16_f32 v20, v48, v49
    v_exp_f32 v52, v52
    v_exp_f32 v53, v53
    v_cvt_pk_bf16_f32 v21, v50, v51
    v_exp_f32 v54, v54
    v_exp_f32 v55, v55
    v_cvt_pk_bf16_f32 v22, v52, v53
    s_add_u32 s59, s59, 1
    s_add_u32 s62, s59, 1
    s_add_u32 s58, s11, s62
    s_and_b32 s58, s58, 15
    s_lshl_b32 s58, s58, 12
    s_add_u32 s55, s56, s58
    buffer_load_dwordx4 v[140:143], v3, s[24:27], s55 offen sc1
    v_cvt_pk_bf16_f32 v23, v54, v55
    v_mfma_f32_32x32x16_bf16 v[40:55], v[136:139], v[60:63], 0
    v_exp_f32 v24, v24
    v_exp_f32 v25, v25
    v_exp_f32 v26, v26
    v_exp_f32 v27, v27
    v_cvt_pk_bf16_f32 v16, v24, v25
    v_mfma_f32_32x32x16_bf16 v[120:135], v[156:159], v[20:23], v[120:135]
    v_exp_f32 v28, v28
    v_exp_f32 v29, v29
    v_cvt_pk_bf16_f32 v17, v26, v27
    v_exp_f32 v30, v30
    v_exp_f32 v31, v31
    v_cvt_pk_bf16_f32 v18, v28, v29
    v_exp_f32 v32, v32
    v_cvt_pk_bf16_f32 v19, v30, v31
    v_exp_f32 v33, v33
    s_waitcnt vmcnt(1)
    v_exp_f32 v34, v34
    v_mfma_f32_32x32x16_bf16 v[72:87], v[144:147], v[16:19], v[72:87]
    v_exp_f32 v35, v35
    v_cvt_pk_bf16_f32 v20, v32, v33
    v_exp_f32 v36, v36
    v_exp_f32 v37, v37
    v_cvt_pk_bf16_f32 v21, v34, v35
    v_exp_f32 v38, v38
    v_exp_f32 v39, v39
    v_cvt_pk_bf16_f32 v22, v36, v37
    s_add_u32 s55, s57, s58
    s_mov_b64 exec, s[60:61]
    buffer_load_dwordx4 v[152:155], v12, s[24:27], s55 offen sc1
    buffer_load_dwordx4 v[156:159], v12, s[24:27], s55 offen offset:512 sc1
    s_mov_b64 exec, -1
    v_cvt_pk_bf16_f32 v23, v38, v39
    v_mfma_f32_32x32x16_bf16 v[24:39], v[136:139], v[64:67], 0
    v_exp_f32 v40, v40
    v_exp_f32 v41, v41
    v_exp_f32 v42, v42
    v_exp_f32 v43, v43
    v_cvt_pk_bf16_f32 v16, v40, v41
    v_mfma_f32_32x32x16_bf16 v[72:87], v[148:151], v[20:23], v[72:87]
    v_exp_f32 v44, v44
    v_exp_f32 v45, v45
    v_cvt_pk_bf16_f32 v17, v42, v43
    v_exp_f32 v46, v46
    v_exp_f32 v47, v47
    v_cvt_pk_bf16_f32 v18, v44, v45
    v_exp_f32 v48, v48
    v_cvt_pk_bf16_f32 v19, v46, v47
    v_exp_f32 v49, v49
    v_exp_f32 v50, v50
    v_mfma_f32_32x32x16_bf16 v[88:103], v[144:147], v[16:19], v[88:103]
    v_exp_f32 v51, v51
    v_cvt_pk_bf16_f32 v20, v48, v49
    v_exp_f32 v52, v52
    v_exp_f32 v53, v53
    v_cvt_pk_bf16_f32 v21, v50, v51
    v_exp_f32 v54, v54
    v_exp_f32 v55, v55
    v_cvt_pk_bf16_f32 v22, v52, v53
    s_nop 0
    v_cvt_pk_bf16_f32 v23, v54, v55
    v_mfma_f32_32x32x16_bf16 v[40:55], v[136:139], v[68:71], 0
    v_exp_f32 v24, v24
    v_exp_f32 v25, v25
    v_exp_f32 v26, v26
    v_exp_f32 v27, v27
    v_cvt_pk_bf16_f32 v16, v24, v25
    v_mfma_f32_32x32x16_bf16 v[88:103], v[148:151], v[20:23], v[88:103]
    v_exp_f32 v28, v28
    v_exp_f32 v29, v29
    v_cvt_pk_bf16_f32 v17, v26, v27
    v_exp_f32 v30, v30
    v_exp_f32 v31, v31
    v_cvt_pk_bf16_f32 v18, v28, v29
    v_exp_f32 v32, v32
    v_cvt_pk_bf16_f32 v19, v30, v31
    v_exp_f32 v33, v33
    v_exp_f32 v34, v34
    v_mfma_f32_32x32x16_bf16 v[104:119], v[144:147], v[16:19], v[104:119]
    v_exp_f32 v35, v35
    v_cvt_pk_bf16_f32 v20, v32, v33
    v_exp_f32 v36, v36
    v_exp_f32 v37, v37
    v_cvt_pk_bf16_f32 v21, v34, v35
    v_exp_f32 v38, v38
    v_exp_f32 v39, v39
    v_cvt_pk_bf16_f32 v22, v36, v37
    s_nop 0
    v_cvt_pk_bf16_f32 v23, v38, v39
    s_waitcnt vmcnt(2)
    v_mfma_f32_32x32x16_bf16 v[24:39], v[140:143], v[56:59], 0
    v_exp_f32 v40, v40
    v_exp_f32 v41, v41
    v_exp_f32 v42, v42
    v_exp_f32 v43, v43
    v_cvt_pk_bf16_f32 v16, v40, v41
    v_mfma_f32_32x32x16_bf16 v[104:119], v[148:151], v[20:23], v[104:119]
    v_exp_f32 v44, v44
    v_exp_f32 v45, v45
    v_cvt_pk_bf16_f32 v17, v42, v43
    v_exp_f32 v46, v46
    v_exp_f32 v47, v47
    v_cvt_pk_bf16_f32 v18, v44, v45
    v_exp_f32 v48, v48
    v_cvt_pk_bf16_f32 v19, v46, v47
    v_exp_f32 v49, v49
    v_exp_f32 v50, v50
    v_mfma_f32_32x32x16_bf16 v[120:135], v[144:147], v[16:19], v[120:135]
    v_exp_f32 v51, v51
    v_cvt_pk_bf16_f32 v20, v48, v49
    v_exp_f32 v52, v52
    v_exp_f32 v53, v53
    v_cvt_pk_bf16_f32 v21, v50, v51
    v_exp_f32 v54, v54
    v_exp_f32 v55, v55
    v_cvt_pk_bf16_f32 v22, v52, v53
    s_add_u32 s59, s59, 1
    s_add_u32 s62, s59, 1
    s_add_u32 s58, s11, s62
    s_and_b32 s58, s58, 15
    s_lshl_b32 s58, s58, 12
    s_add_u32 s55, s56, s58
    buffer_load_dwordx4 v[136:139], v3, s[24:27], s55 offen sc1
    s_cmp_lt_u32 s59, 13
    v_cvt_pk_bf16_f32 v23, v54, v55
    s_cbranch_scc1 L_loopf
    v_mfma_f32_32x32x16_bf16 v[40:55], v[140:143], v[60:63], 0
    v_exp_f32 v24, v24
    v_exp_f32 v25, v25
    v_exp_f32 v26, v26
    v_exp_f32 v27, v27
    v_cvt_pk_bf16_f32 v16, v24, v25
    v_mfma_f32_32x32x16_bf16 v[120:135], v[148:151], v[20:23], v[120:135]
    v_exp_f32 v28, v28
    v_exp_f32 v29, v29
    v_cvt_pk_bf16_f32 v17, v26, v27
    v_exp_f32 v30, v30
    v_exp_f32 v31, v31
    v_cvt_pk_bf16_f32 v18, v28, v29
    v_exp_f32 v32, v32
    v_cvt_pk_bf16_f32 v19, v30, v31
    v_exp_f32 v33, v33
    s_waitcnt vmcnt(1)
    v_exp_f32 v34, v34
    v_mfma_f32_32x32x16_bf16 v[72:87], v[152:155], v[16:19], v[72:87]
    v_exp_f32 v35, v35
    v_cvt_pk_bf16_f32 v20, v32, v33
    v_exp_f32 v36, v36
    v_exp_f32 v37, v37
    v_cvt_pk_bf16_f32 v21, v34, v35
    v_exp_f32 v38, v38
    v_exp_f32 v39, v39
    v_cvt_pk_bf16_f32 v22, v36, v37
    s_add_u32 s55, s57, s58
    s_mov_b64 exec, s[60:61]
    buffer_load_dwordx4 v[144:147], v12, s[24:27], s55 offen sc1
    buffer_load_dwordx4 v[148:151], v12, s[24:27], s55 offen offset:512 sc1
    s_mov_b64 exec, -1
    v_cvt_pk_bf16_f32 v23, v38, v39
    v_mfma_f32_32x32x16_bf16 v[24:39], v[140:143], v[64:67], 0
    v_exp_f32 v40, v40
    v_exp_f32 v41, v41
    v_exp_f32 v42, v42
    v_exp_f32 v43, v43
    v_cvt_pk_bf16_f32 v16, v40, v41
    v_mfma_f32_32x32x16_bf16 v[72:87], v[156:159], v[20:23], v[72:87]
    v_exp_f32 v44, v44
    v_exp_f32 v45, v45
    v_cvt_pk_bf16_f32 v17, v42, v43
    v_exp_f32 v46, v46
    v_exp_f32 v47, v47
    v_cvt_pk_bf16_f32 v18, v44, v45
    v_exp_f32 v48, v48
    v_cvt_pk_bf16_f32 v19, v46, v47
    v_exp_f32 v49, v49
    v_exp_f32 v50, v50
    v_mfma_f32_32x32x16_bf16 v[88:103], v[152:155], v[16:19], v[88:103]
    v_exp_f32 v51, v51
    v_cvt_pk_bf16_f32 v20, v48, v49
    v_exp_f32 v52, v52
    v_exp_f32 v53, v53
    v_cvt_pk_bf16_f32 v21, v50, v51
    v_exp_f32 v54, v54
    v_exp_f32 v55, v55
    v_cvt_pk_bf16_f32 v22, v52, v53
    s_nop 0
    v_cvt_pk_bf16_f32 v23, v54, v55
    v_mfma_f32_32x32x16_bf16 v[40:55], v[140:143], v[68:71], 0
    v_exp_f32 v24, v24
    v_exp_f32 v25, v25
    v_exp_f32 v26, v26
    v_exp_f32 v27, v27
    v_cvt_pk_bf16_f32 v16, v24, v25
    v_mfma_f32_32x32x16_bf16 v[88:103], v[156:159], v[20:23], v[88:103]
    v_exp_f32 v28, v28
    v_exp_f32 v29, v29
    v_cvt_pk_bf16_f32 v17, v26, v27
    v_exp_f32 v30, v30
    v_exp_f32 v31, v31
    v_cvt_pk_bf16_f32 v18, v28, v29
    v_exp_f32 v32, v32
    v_cvt_pk_bf16_f32 v19, v30, v31
    v_exp_f32 v33, v33
    v_exp_f32 v34, v34
    v_mfma_f32_32x32x16_bf16 v[104:119], v[152:155], v[16:19], v[104:119]
    v_exp_f32 v35, v35
    v_cvt_pk_bf16_f32 v20, v32, v33
    v_exp_f32 v36, v36
    v_exp_f32 v37, v37
    v_cvt_pk_bf16_f32 v21, v34, v35
    v_exp_f32 v38, v38
    v_exp_f32 v39, v39
    v_cvt_pk_bf16_f32 v22, v36, v37
    s_nop 0
    v_cvt_pk_bf16_f32 v23, v38, v39
    s_waitcnt vmcnt(2)
    v_mfma_f32_32x32x16_bf16 v[24:39], v[136:139], v[56:59], 0
    v_exp_f32 v40, v40
    v_exp_f32 v41, v41
    v_exp_f32 v42, v42
    v_exp_f32 v43, v43
    v_cvt_pk_bf16_f32 v16, v40, v41
    v_mfma_f32_32x32x16_bf16 v[104:119], v[156:159], v[20:23], v[104:119]
    v_exp_f32 v44, v44
    v_exp_f32 v45, v45
    v_cvt_pk_bf16_f32 v17, v42, v43
    v_exp_f32 v46, v46
    v_exp_f32 v47, v47
    v_cvt_pk_bf16_f32 v18, v44, v45
    v_exp_f32 v48, v48
    v_cvt_pk_bf16_f32 v19, v46, v47
    v_exp_f32 v49, v49
    v_exp_f32 v50, v50
    v_mfma_f32_32x32x16_bf16 v[120:135], v[152:155], v[16:19], v[120:135]
    v_exp_f32 v51, v51
    v_cvt_pk_bf16_f32 v20, v48, v49
    v_exp_f32 v52, v52
    v_exp_f32 v53, v53
    v_cvt_pk_bf16_f32 v21, v50, v51
    v_exp_f32 v54, v54
    v_exp_f32 v55, v55
    v_cvt_pk_bf16_f32 v22, v52, v53
    s_add_u32 s59, s59, 1
    s_add_u32 s62, s59, 1
    s_add_u32 s58, s11, s62
    s_and_b32 s58, s58, 15
    s_lshl_b32 s58, s58, 12
    s_add_u32 s55, s56, s58
    buffer_load_dwordx4 v[140:143], v3, s[24:27], s55 offen sc1
    v_cvt_pk_bf16_f32 v23, v54, v55
    v_mfma_f32_32x32x16_bf16 v[40:55], v[136:139], v[60:63], 0
    v_exp_f32 v24, v24
    v_exp_f32 v25, v25
    v_exp_f32 v26, v26
    v_exp_f32 v27, v27
    v_cvt_pk_bf16_f32 v16, v24, v25
    v_mfma_f32_32x32x16_bf16 v[120:135], v[156:159], v[20:23], v[120:135]
    v_exp_f32 v28, v28
    v_exp_f32 v29, v29
    v_cvt_pk_bf16_f32 v17, v26, v27
    v_exp_f32 v30, v30
    v_exp_f32 v31, v31
    v_cvt_pk_bf16_f32 v18, v28, v29
    v_exp_f32 v32, v32
    v_cvt_pk_bf16_f32 v19, v30, v31
    v_exp_f32 v33, v33
    s_waitcnt vmcnt(1)
    v_exp_f32 v34, v34
    v_mfma_f32_32x32x16_bf16 v[72:87], v[144:147], v[16:19], v[72:87]
    v_exp_f32 v35, v35
    v_cvt_pk_bf16_f32 v20, v32, v33
    v_exp_f32 v36, v36
    v_exp_f32 v37, v37
    v_cvt_pk_bf16_f32 v21, v34, v35
    v_exp_f32 v38, v38
    v_exp_f32 v39, v39
    v_cvt_pk_bf16_f32 v22, v36, v37
    s_add_u32 s55, s57, s58
    s_mov_b64 exec, s[60:61]
    buffer_load_dwordx4 v[152:155], v12, s[24:27], s55 offen sc1
    buffer_load_dwordx4 v[156:159], v12, s[24:27], s55 offen offset:512 sc1
    s_mov_b64 exec, -1
    v_cvt_pk_bf16_f32 v23, v38, v39
    v_mfma_f32_32x32x16_bf16 v[24:39], v[136:139], v[64:67], 0
    v_exp_f32 v40, v40
    v_exp_f32 v41, v41
    v_exp_f32 v42, v42
    v_exp_f32 v43, v43
    v_cvt_pk_bf16_f32 v16, v40, v41
    v_mfma_f32_32x32x16_bf16 v[72:87], v[148:151], v[20:23], v[72:87]
    v_exp_f32 v44, v44
    v_exp_f32 v45, v45
    v_cvt_pk_bf16_f32 v17, v42, v43
    v_exp_f32 v46, v46
    v_exp_f32 v47, v47
    v_cvt_pk_bf16_f32 v18, v44, v45
    v_exp_f32 v48, v48
    v_cvt_pk_bf16_f32 v19, v46, v47
    v_exp_f32 v49, v49
    v_exp_f32 v50, v50
    v_mfma_f32_32x32x16_bf16 v[88:103], v[144:147], v[16:19], v[88:103]
    v_exp_f32 v51, v51
    v_cvt_pk_bf16_f32 v20, v48, v49
    v_exp_f32 v52, v52
    v_exp_f32 v53, v53
    v_cvt_pk_bf16_f32 v21, v50, v51
    v_exp_f32 v54, v54
    v_exp_f32 v55, v55
    v_cvt_pk_bf16_f32 v22, v52, v53
    s_nop 0
    v_cvt_pk_bf16_f32 v23, v54, v55
    v_mfma_f32_32x32x16_bf16 v[40:55], v[136:139], v[68:71], 0
    v_exp_f32 v24, v24
    v_exp_f32 v25, v25
    v_exp_f32 v26, v26
    v_exp_f32 v27, v27
    v_cvt_pk_bf16_f32 v16, v24, v25
    v_mfma_f32_32x32x16_bf16 v[88:103], v[148:151], v[20:23], v[88:103]
    v_exp_f32 v28, v28
    v_exp_f32 v29, v29
    v_cvt_pk_bf16_f32 v17, v26, v27
    v_exp_f32 v30, v30
    v_exp_f32 v31, v31
    v_cvt_pk_bf16_f32 v18, v28, v29
    v_exp_f32 v32, v32
    v_cvt_pk_bf16_f32 v19, v30, v31
    v_exp_f32 v33, v33
    v_exp_f32 v34, v34
    v_mfma_f32_32x32x16_bf16 v[104:119], v[144:147], v[16:19], v[104:119]
    v_exp_f32 v35, v35
    v_cvt_pk_bf16_f32 v20, v32, v33
    v_exp_f32 v36, v36
    v_exp_f32 v37, v37
    v_cvt_pk_bf16_f32 v21, v34, v35
    v_exp_f32 v38, v38
    v_exp_f32 v39, v39
    v_cvt_pk_bf16_f32 v22, v36, v37
    s_nop 0
    v_cvt_pk_bf16_f32 v23, v38, v39
    s_waitcnt vmcnt(2)
    v_mfma_f32_32x32x16_bf16 v[24:39], v[140:143], v[56:59], 0
    v_exp_f32 v40, v40
    v_exp_f32 v41, v41
    v_exp_f32 v42, v42
    v_exp_f32 v43, v43
    v_cvt_pk_bf16_f32 v16, v40, v41
    v_mfma_f32_32x32x16_bf16 v[104:119], v[148:151], v[20:23], v[104:119]
    v_exp_f32 v44, v44
    v_exp_f32 v45, v45
    v_cvt_pk_bf16_f32 v17, v42, v43
    v_exp_f32 v46, v46
    v_exp_f32 v47, v47
    v_cvt_pk_bf16_f32 v18, v44, v45
    v_exp_f32 v48, v48
    v_cvt_pk_bf16_f32 v19, v46, v47
    v_exp_f32 v49, v49
    v_exp_f32 v50, v50
    v_mfma_f32_32x32x16_bf16 v[120:135], v[144:147], v[16:19], v[120:135]
    v_exp_f32 v51, v51
    v_cvt_pk_bf16_f32 v20, v48, v49
    v_exp_f32 v52, v52
    v_exp_f32 v53, v53
    v_cvt_pk_bf16_f32 v21, v50, v51
    v_exp_f32 v54, v54
    v_exp_f32 v55, v55
    v_cvt_pk_bf16_f32 v22, v52, v53
    s_nop 0
    v_cvt_pk_bf16_f32 v23, v54, v55
    v_mfma_f32_32x32x16_bf16 v[40:55], v[140:143], v[60:63], 0
    v_exp_f32 v24, v24
    v_exp_f32 v25, v25
    v_exp_f32 v26, v26
    v_exp_f32 v27, v27
    v_cvt_pk_bf16_f32 v16, v24, v25
    v_mfma_f32_32x32x16_bf16 v[120:135], v[148:151], v[20:23], v[120:135]
    v_exp_f32 v28, v28
    v_exp_f32 v29, v29
    v_cvt_pk_bf16_f32 v17, v26, v27
    v_exp_f32 v30, v30
    v_exp_f32 v31, v31
    v_cvt_pk_bf16_f32 v18, v28, v29
    v_exp_f32 v32, v32
    v_cvt_pk_bf16_f32 v19, v30, v31
    v_exp_f32 v33, v33
    s_waitcnt vmcnt(0)
    v_exp_f32 v34, v34
    v_mfma_f32_32x32x16_bf16 v[72:87], v[152:155], v[16:19], v[72:87]
    v_exp_f32 v35, v35
    v_cvt_pk_bf16_f32 v20, v32, v33
    v_exp_f32 v36, v36
    v_exp_f32 v37, v37
    v_cvt_pk_bf16_f32 v21, v34, v35
    v_exp_f32 v38, v38
    v_exp_f32 v39, v39
    v_cvt_pk_bf16_f32 v22, v36, v37
    s_nop 0
    v_cvt_pk_bf16_f32 v23, v38, v39
    v_mfma_f32_32x32x16_bf16 v[24:39], v[140:143], v[64:67], 0
    v_exp_f32 v40, v40
    v_exp_f32 v41, v41
    v_exp_f32 v42, v42
    v_exp_f32 v43, v43
    v_cvt_pk_bf16_f32 v16, v40, v41
    v_mfma_f32_32x32x16_bf16 v[72:87], v[156:159], v[20:23], v[72:87]
    v_exp_f32 v44, v44
    v_exp_f32 v45, v45
    v_cvt_pk_bf16_f32 v17, v42, v43
    v_exp_f32 v46, v46
    v_exp_f32 v47, v47
    v_cvt_pk_bf16_f32 v18, v44, v45
    v_exp_f32 v48, v48
    v_cvt_pk_bf16_f32 v19, v46, v47
    v_exp_f32 v49, v49
    v_exp_f32 v50, v50
    v_mfma_f32_32x32x16_bf16 v[88:103], v[152:155], v[16:19], v[88:103]
    v_exp_f32 v51, v51
    v_cvt_pk_bf16_f32 v20, v48, v49
    v_exp_f32 v52, v52
    v_exp_f32 v53, v53
    v_cvt_pk_bf16_f32 v21, v50, v51
    v_exp_f32 v54, v54
    v_exp_f32 v55, v55
    v_cvt_pk_bf16_f32 v22, v52, v53
    s_nop 0
    v_cvt_pk_bf16_f32 v23, v54, v55
    v_mfma_f32_32x32x16_bf16 v[40:55], v[140:143], v[68:71], 0
    v_exp_f32 v24, v24
    v_exp_f32 v25, v25
    v_exp_f32 v26, v26
    v_exp_f32 v27, v27
    v_cvt_pk_bf16_f32 v16, v24, v25
    v_mfma_f32_32x32x16_bf16 v[88:103], v[156:159], v[20:23], v[88:103]
    v_exp_f32 v28, v28
    v_exp_f32 v29, v29
    v_cvt_pk_bf16_f32 v17, v26, v27
    v_exp_f32 v30, v30
    v_exp_f32 v31, v31
    v_cvt_pk_bf16_f32 v18, v28, v29
    v_exp_f32 v32, v32
    v_cvt_pk_bf16_f32 v19, v30, v31
    v_exp_f32 v33, v33
    v_exp_f32 v34, v34
    v_mfma_f32_32x32x16_bf16 v[104:119], v[152:155], v[16:19], v[104:119]
    v_exp_f32 v35, v35
    v_cvt_pk_bf16_f32 v20, v32, v33
    v_exp_f32 v36, v36
    v_exp_f32 v37, v37
    v_cvt_pk_bf16_f32 v21, v34, v35
    v_exp_f32 v38, v38
    v_exp_f32 v39, v39
    v_cvt_pk_bf16_f32 v22, v36, v37
    s_nop 0
    v_cvt_pk_bf16_f32 v23, v38, v39
    v_exp_f32 v40, v40
    v_exp_f32 v41, v41
    v_exp_f32 v42, v42
    v_exp_f32 v43, v43
    v_cvt_pk_bf16_f32 v16, v40, v41
    v_mfma_f32_32x32x16_bf16 v[104:119], v[156:159], v[20:23], v[104:119]
    v_exp_f32 v44, v44
    v_exp_f32 v45, v45
    v_cvt_pk_bf16_f32 v17, v42, v43
    v_exp_f32 v46, v46
    v_exp_f32 v47, v47
    v_cvt_pk_bf16_f32 v18, v44, v45
    v_exp_f32 v48, v48
    v_cvt_pk_bf16_f32 v19, v46, v47
    v_exp_f32 v49, v49
    v_exp_f32 v50, v50
    v_mfma_f32_32x32x16_bf16 v[120:135], v[152:155], v[16:19], v[120:135]
    v_exp_f32 v51, v51
    v_cvt_pk_bf16_f32 v20, v48, v49
    v_exp_f32 v52, v52
    v_exp_f32 v53, v53
    v_cvt_pk_bf16_f32 v21, v50, v51
    v_exp_f32 v54, v54
    v_exp_f32 v55, v55
    v_cvt_pk_bf16_f32 v22, v52, v53
    s_nop 0
    v_cvt_pk_bf16_f32 v23, v54, v55
    s_nop 1
    v_mfma_f32_32x32x16_bf16 v[120:135], v[156:159], v[20:23], v[120:135]
    s_branch L_attn_fin
L_slow0:
    v_lshlrev_b32 v10, 4, v4
L_pkv_30:
    s_cmp_eq_u32 s53, 0
    s_cbranch_scc1 L_pkvo_31
    s_sub_u32 s53, s53, 1
    buffer_load_dwordx4 v[164:167], v10, s[24:27], s63 offen sc1
L_pkvc_32:
    s_waitcnt vmcnt(0)
    v_cmp_eq_u32 vcc, s52, v164
    v_cmp_eq_u32 s[54:55], s52, v167
    s_and_b64 vcc, vcc, s[54:55]
    s_cmp_eq_u64 vcc, exec
    s_cbranch_scc0 L_pkv_30
L_pkvo_31:
L_slow1:
    v_mov_b32 v6, 162856
    v_mov_b32 v7, 1
    s_mov_b64 exec, 1
    ds_add_u32 v6, v7
    s_mov_b64 exec, -1
    v_mov_b32 v160, 0xff800000
    v_mov_b32 v161, 0xff800000
    v_mov_b32 v162, 0xff800000
    v_mov_b32 v163, 0xff800000
    s_mov_b32 s59, 0
L_maxloop:
    s_add_u32 s58, s11, s59
    s_and_b32 s58, s58, 15
    s_lshl_b32 s58, s58, 12
    s_add_u32 s55, s56, s58
    buffer_load_dwordx4 v[136:139], v3, s[24:27], s55 offen sc1
    s_waitcnt vmcnt(0)
    v_mfma_f32_32x32x16_bf16 v[24:39], v[136:139], v[56:59], 0
    s_nop 15
    v_max3_f32 v160, v24, v25, v160
    v_max3_f32 v160, v26, v27, v160
    v_max3_f32 v160, v28, v29, v160
    v_max3_f32 v160, v30, v31, v160
    v_max3_f32 v160, v32, v33, v160
    v_max3_f32 v160, v34, v35, v160
    v_max3_f32 v160, v36, v37, v160
    v_max3_f32 v160, v38, v39, v160
    v_mfma_f32_32x32x16_bf16 v[24:39], v[136:139], v[60:63], 0
    s_nop 15
    v_max3_f32 v161, v24, v25, v161
    v_max3_f32 v161, v26, v27, v161
    v_max3_f32 v161, v28, v29, v161
    v_max3_f32 v161, v30, v31, v161
    v_max3_f32 v161, v32, v33, v161
    v_max3_f32 v161, v34, v35, v161
    v_max3_f32 v161, v36, v37, v161
    v_max3_f32 v161, v38, v39, v161
    v_mfma_f32_32x32x16_bf16 v[24:39], v[136:139], v[64:67], 0
    s_nop 15
    v_max3_f32 v162, v24, v25, v162
    v_max3_f32 v162, v26, v27, v162
    v_max3_f32 v162, v28, v29, v162
    v_max3_f32 v162, v30, v31, v162
    v_max3_f32 v162, v32, v33, v162
    v_max3_f32 v162, v34, v35, v162
    v_max3_f32 v162, v36, v37, v162
    v_max3_f32 v162, v38, v39, v162
    v_mfma_f32_32x32x16_bf16 v[24:39], v[136:139], v[68:71], 0
    s_nop 15
    v_max3_f32 v163, v24, v25, v163
    v_max3_f32 v163, v26, v27, v163
    v_max3_f32 v163, v28, v29, v163
    v_max3_f32 v163, v30, v31, v163
    v_max3_f32 v163, v32, v33, v163
    v_max3_f32 v163, v34, v35, v163
    v_max3_f32 v163, v36, v37, v163
    v_max3_f32 v163, v38, v39, v163
    s_add_u32 s59, s59, 1
    s_cmp_lt_u32 s59, 16
    s_cbranch_scc1 L_maxloop
    v_mov_b32 v6, v160
    s_nop 1
    v_permlane32_swap_b32 v160, v6
    v_max_f32 v160, v160, v6
    v_sub_f32 v160, 0, v160
    v_mov_b32 v72, 0
    v_mov_b32 v73, 0
    v_mov_b32 v74, 0
    v_mov_b32 v75, 0
    v_mov_b32 v76, 0
    v_mov_b32 v77, 0
    v_mov_b32 v78, 0
    v_mov_b32 v79, 0
    v_mov_b32 v80, 0
    v_mov_b32 v81, 0
    v_mov_b32 v82, 0
    v_mov_b32 v83, 0
    v_mov_b32 v84, 0
    v_mov_b32 v85, 0
    v_mov_b32 v86, 0
    v_mov_b32 v87, 0
    v_mov_b32 v6, v161
    s_nop 1
    v_permlane32_swap_b32 v161, v6
    v_max_f32 v161, v161, v6
    v_sub_f32 v161, 0, v161
    v_mov_b32 v88, 0
    v_mov_b32 v89, 0
    v_mov_b32 v90, 0
    v_mov_b32 v91, 0
    v_mov_b32 v92, 0
    v_mov_b32 v93, 0
    v_mov_b32 v94, 0
    v_mov_b32 v95, 0
    v_mov_b32 v96, 0
    v_mov_b32 v97, 0
    v_mov_b32 v98, 0
    v_mov_b32 v99, 0
    v_mov_b32 v100, 0
    v_mov_b32 v101, 0
    v_mov_b32 v102, 0
    v_mov_b32 v103, 0
    v_mov_b32 v6, v162
    s_nop 1
    v_permlane32_swap_b32 v162, v6
    v_max_f32 v162, v162, v6
    v_sub_f32 v162, 0, v162
    v_mov_b32 v104, 0
    v_mov_b32 v105, 0
    v_mov_b32 v106, 0
    v_mov_b32 v107, 0
    v_mov_b32 v108, 0
    v_mov_b32 v109, 0
    v_mov_b32 v110, 0
    v_mov_b32 v111, 0
    v_mov_b32 v112, 0
    v_mov_b32 v113, 0
    v_mov_b32 v114, 0
    v_mov_b32 v115, 0
    v_mov_b32 v116, 0
    v_mov_b32 v117, 0
    v_mov_b32 v118, 0
    v_mov_b32 v119, 0
    v_mov_b32 v6, v163
    s_nop 1
    v_permlane32_swap_b32 v163, v6
    v_max_f32 v163, v163, v6
    v_sub_f32 v163, 0, v163
    v_mov_b32 v120, 0
    v_mov_b32 v121, 0
    v_mov_b32 v122, 0
    v_mov_b32 v123, 0
    v_mov_b32 v124, 0
    v_mov_b32 v125, 0
    v_mov_b32 v126, 0
    v_mov_b32 v127, 0
    v_mov_b32 v128, 0
    v_mov_b32 v129, 0
    v_mov_b32 v130, 0
    v_mov_b32 v131, 0
    v_mov_b32 v132, 0
    v_mov_b32 v133, 0
    v_mov_b32 v134, 0
    v_mov_b32 v135, 0
    v_mov_b32 v16, 0
    v_mov_b32 v17, 0
    v_mov_b32 v18, 0
    v_mov_b32 v19, 0
    v_mov_b32 v20, 0
    v_mov_b32 v21, 0
    v_mov_b32 v22, 0
    v_mov_b32 v23, 0
    s_add_u32 s58, s11, 0
    s_and_b32 s58, s58, 15
    s_lshl_b32 s58, s58, 12
    s_add_u32 s55, s56, s58
    buffer_load_dwordx4 v[136:139], v3, s[24:27], s55 offen sc1
    s_add_u32 s55, s57, s58
    s_mov_b64 exec, s[60:61]
    buffer_load_dwordx4 v[144:147], v12, s[24:27], s55 offen sc1
    buffer_load_dwordx4 v[148:151], v12, s[24:27], s55 offen offset:512 sc1
    s_mov_b64 exec, -1
    s_add_u32 s58, s11, 1
    s_and_b32 s58, s58, 15
    s_lshl_b32 s58, s58, 12
    s_add_u32 s55, s56, s58
    buffer_load_dwordx4 v[140:143], v3, s[24:27], s55 offen sc1
    s_waitcnt vmcnt(3)
    v_mfma_f32_32x32x16_bf16 v[24:39], v[136:139], v[56:59], 0
    s_mov_b32 s59, 0
    s_nop 15
L_loops:
    v_mfma_f32_32x32x16_bf16 v[40:55], v[136:139], v[60:63], 0
    v_add_f32 v24, v160, v24
    v_exp_f32 v24, v24
    v_add_f32 v25, v160, v25
    v_exp_f32 v25, v25
    v_add_f32 v26, v160, v26
    v_exp_f32 v26, v26
    v_add_f32 v27, v160, v27
    v_exp_f32 v27, v27
    v_cvt_pk_bf16_f32 v16, v24, v25
    v_mfma_f32_32x32x16_bf16 v[120:135], v[156:159], v[20:23], v[120:135]
    v_add_f32 v28, v160, v28
    v_exp_f32 v28, v28
    v_add_f32 v29, v160, v29
    v_exp_f32 v29, v29
    v_cvt_pk_bf16_f32 v17, v26, v27
    v_add_f32 v30, v160, v30
    v_exp_f32 v30, v30
    v_add_f32 v31, v160, v31
    v_exp_f32 v31, v31
    v_cvt_pk_bf16_f32 v18, v28, v29
    v_add_f32 v32, v160, v32
    v_exp_f32 v32, v32
    v_cvt_pk_bf16_f32 v19, v30, v31
    v_add_f32 v33, v160, v33
    v_exp_f32 v33, v33
    s_waitcnt vmcnt(1)
    v_add_f32 v34, v160, v34
    v_exp_f32 v34, v34
    v_mfma_f32_32x32x16_bf16 v[72:87], v[144:147], v[16:19], v[72:87]
    v_add_f32 v35, v160, v35
    v_exp_f32 v35, v35
    v_cvt_pk_bf16_f32 v20, v32, v33
    v_add_f32 v36, v160, v36
    v_exp_f32 v36, v36
    v_add_f32 v37, v160, v37
    v_exp_f32 v37, v37
    v_cvt_pk_bf16_f32 v21, v34, v35
    v_add_f32 v38, v160, v38
    v_exp_f32 v38, v38
    v_add_f32 v39, v160, v39
    v_exp_f32 v39, v39
    v_cvt_pk_bf16_f32 v22, v36, v37
    s_add_u32 s55, s57, s58
    s_mov_b64 exec, s[60:61]
    buffer_load_dwordx4 v[152:155], v12, s[24:27], s55 offen sc1
    buffer_load_dwordx4 v[156:159], v12, s[24:27], s55 offen offset:512 sc1
    s_mov_b64 exec, -1
    v_cvt_pk_bf16_f32 v23, v38, v39
    v_mfma_f32_32x32x16_bf16 v[24:39], v[136:139], v[64:67], 0
    v_add_f32 v40, v161, v40
    v_exp_f32 v40, v40
    v_add_f32 v41, v161, v41
    v_exp_f32 v41, v41
    v_add_f32 v42, v161, v42
    v_exp_f32 v42, v42
    v_add_f32 v43, v161, v43
    v_exp_f32 v43, v43
    v_cvt_pk_bf16_f32 v16, v40, v41
    v_mfma_f32_32x32x16_bf16 v[72:87], v[148:151], v[20:23], v[72:87]
    v_add_f32 v44, v161, v44
    v_exp_f32 v44, v44
    v_add_f32 v45, v161, v45
    v_exp_f32 v45, v45
    v_cvt_pk_bf16_f32 v17, v42, v43
    v_add_f32 v46, v161, v46
    v_exp_f32 v46, v46
    v_add_f32 v47, v161, v47
    v_exp_f32 v47, v47
    v_cvt_pk_bf16_f32 v18, v44, v45
    v_add_f32 v48, v161, v48
    v_exp_f32 v48, v48
    v_cvt_pk_bf16_f32 v19, v46, v47
    v_add_f32 v49, v161, v49
    v_exp_f32 v49, v49
    v_add_f32 v50, v161, v50
    v_exp_f32 v50, v50
    v_mfma_f32_32x32x16_bf16 v[88:103], v[144:147], v[16:19], v[88:103]
    v_add_f32 v51, v161, v51
    v_exp_f32 v51, v51
    v_cvt_pk_bf16_f32 v20, v48, v49
    v_add_f32 v52, v161, v52
    v_exp_f32 v52, v52
    v_add_f32 v53, v161, v53
    v_exp_f32 v53, v53
    v_cvt_pk_bf16_f32 v21, v50, v51
    v_add_f32 v54, v161, v54
    v_exp_f32 v54, v54
    v_add_f32 v55, v161, v55
    v_exp_f32 v55, v55
    v_cvt_pk_bf16_f32 v22, v52, v53
    s_nop 0
    v_cvt_pk_bf16_f32 v23, v54, v55
    v_mfma_f32_32x32x16_bf16 v[40:55], v[136:139], v[68:71], 0
    v_add_f32 v24, v162, v24
    v_exp_f32 v24, v24
    v_add_f32 v25, v162, v25
    v_exp_f32 v25, v25
    v_add_f32 v26, v162, v26
    v_exp_f32 v26, v26
    v_add_f32 v27, v162, v27
    v_exp_f32 v27, v27
    v_cvt_pk_bf16_f32 v16, v24, v25
    v_mfma_f32_32x32x16_bf16 v[88:103], v[148:151], v[20:23], v[88:103]
    v_add_f32 v28, v162, v28
    v_exp_f32 v28, v28
    v_add_f32 v29, v162, v29
    v_exp_f32 v29, v29
    v_cvt_pk_bf16_f32 v17, v26, v27
    v_add_f32 v30, v162, v30
    v_exp_f32 v30, v30
    v_add_f32 v31, v162, v31
    v_exp_f32 v31, v31
    v_cvt_pk_bf16_f32 v18, v28, v29
    v_add_f32 v32, v162, v32
    v_exp_f32 v32, v32
    v_cvt_pk_bf16_f32 v19, v30, v31
    v_add_f32 v33, v162, v33
    v_exp_f32 v33, v33
    v_add_f32 v34, v162, v34
    v_exp_f32 v34, v34
    v_mfma_f32_32x32x16_bf16 v[104:119], v[144:147], v[16:19], v[104:119]
    v_add_f32 v35, v162, v35
    v_exp_f32 v35, v35
    v_cvt_pk_bf16_f32 v20, v32, v33
    v_add_f32 v36, v162, v36
    v_exp_f32 v36, v36
    v_add_f32 v37, v162, v37
    v_exp_f32 v37, v37
    v_cvt_pk_bf16_f32 v21, v34, v35
    v_add_f32 v38, v162, v38
    v_exp_f32 v38, v38
    v_add_f32 v39, v162, v39
    v_exp_f32 v39, v39
    v_cvt_pk_bf16_f32 v22, v36, v37
    s_nop 0
    v_cvt_pk_bf16_f32 v23, v38, v39
    s_waitcnt vmcnt(2)
    v_mfma_f32_32x32x16_bf16 v[24:39], v[140:143], v[56:59], 0
    v_add_f32 v40, v163, v40
    v_exp_f32 v40, v40
    v_add_f32 v41, v163, v41
    v_exp_f32 v41, v41
    v_add_f32 v42, v163, v42
    v_exp_f32 v42, v42
    v_add_f32 v43, v163, v43
    v_exp_f32 v43, v43
    v_cvt_pk_bf16_f32 v16, v40, v41
    v_mfma_f32_32x32x16_bf16 v[104:119], v[148:151], v[20:23], v[104:119]
    v_add_f32 v44, v163, v44
    v_exp_f32 v44, v44
    v_add_f32 v45, v163, v45
    v_exp_f32 v45, v45
    v_cvt_pk_bf16_f32 v17, v42, v43
    v_add_f32 v46, v163, v46
    v_exp_f32 v46, v46
    v_add_f32 v47, v163, v47
    v_exp_f32 v47, v47
    v_cvt_pk_bf16_f32 v18, v44, v45
    v_add_f32 v48, v163, v48
    v_exp_f32 v48, v48
    v_cvt_pk_bf16_f32 v19, v46, v47
    v_add_f32 v49, v163, v49
    v_exp_f32 v49, v49
    v_add_f32 v50, v163, v50
    v_exp_f32 v50, v50
    v_mfma_f32_32x32x16_bf16 v[120:135], v[144:147], v[16:19], v[120:135]
    v_add_f32 v51, v163, v51
    v_exp_f32 v51, v51
    v_cvt_pk_bf16_f32 v20, v48, v49
    v_add_f32 v52, v163, v52
    v_exp_f32 v52, v52
    v_add_f32 v53, v163, v53
    v_exp_f32 v53, v53
    v_cvt_pk_bf16_f32 v21, v50, v51
    v_add_f32 v54, v163, v54
    v_exp_f32 v54, v54
    v_add_f32 v55, v163, v55
    v_exp_f32 v55, v55
    v_cvt_pk_bf16_f32 v22, v52, v53
    s_add_u32 s59, s59, 1
    s_add_u32 s62, s59, 1
    s_add_u32 s58, s11, s62
    s_and_b32 s58, s58, 15
    s_lshl_b32 s58, s58, 12
    s_add_u32 s55, s56, s58
    buffer_load_dwordx4 v[136:139], v3, s[24:27], s55 offen sc1
    v_cvt_pk_bf16_f32 v23, v54, v55
    v_mfma_f32_32x32x16_bf16 v[40:55], v[140:143], v[60:63], 0
    v_add_f32 v24, v160, v24
    v_exp_f32 v24, v24
    v_add_f32 v25, v160, v25
    v_exp_f32 v25, v25
    v_add_f32 v26, v160, v26
    v_exp_f32 v26, v26
    v_add_f32 v27, v160, v27
    v_exp_f32 v27, v27
    v_cvt_pk_bf16_f32 v16, v24, v25
    v_mfma_f32_32x32x16_bf16 v[120:135], v[148:151], v[20:23], v[120:135]
    v_add_f32 v28, v160, v28
    v_exp_f32 v28, v28
    v_add_f32 v29, v160, v29
    v_exp_f32 v29, v29
    v_cvt_pk_bf16_f32 v17, v26, v27
    v_add_f32 v30, v160, v30
    v_exp_f32 v30, v30
    v_add_f32 v31, v160, v31
    v_exp_f32 v31, v31
    v_cvt_pk_bf16_f32 v18, v28, v29
    v_add_f32 v32, v160, v32
    v_exp_f32 v32, v32
    v_cvt_pk_bf16_f32 v19, v30, v31
    v_add_f32 v33, v160, v33
    v_exp_f32 v33, v33
    s_waitcnt vmcnt(1)
    v_add_f32 v34, v160, v34
    v_exp_f32 v34, v34
    v_mfma_f32_32x32x16_bf16 v[72:87], v[152:155], v[16:19], v[72:87]
    v_add_f32 v35, v160, v35
    v_exp_f32 v35, v35
    v_cvt_pk_bf16_f32 v20, v32, v33
    v_add_f32 v36, v160, v36
    v_exp_f32 v36, v36
    v_add_f32 v37, v160, v37
    v_exp_f32 v37, v37
    v_cvt_pk_bf16_f32 v21, v34, v35
    v_add_f32 v38, v160, v38
    v_exp_f32 v38, v38
    v_add_f32 v39, v160, v39
    v_exp_f32 v39, v39
    v_cvt_pk_bf16_f32 v22, v36, v37
    s_add_u32 s55, s57, s58
    s_mov_b64 exec, s[60:61]
    buffer_load_dwordx4 v[144:147], v12, s[24:27], s55 offen sc1
    buffer_load_dwordx4 v[148:151], v12, s[24:27], s55 offen offset:512 sc1
    s_mov_b64 exec, -1
    v_cvt_pk_bf16_f32 v23, v38, v39
    v_mfma_f32_32x32x16_bf16 v[24:39], v[140:143], v[64:67], 0
    v_add_f32 v40, v161, v40
    v_exp_f32 v40, v40
    v_add_f32 v41, v161, v41
    v_exp_f32 v41, v41
    v_add_f32 v42, v161, v42
    v_exp_f32 v42, v42
    v_add_f32 v43, v161, v43
    v_exp_f32 v43, v43
    v_cvt_pk_bf16_f32 v16, v40, v41
    v_mfma_f32_32x32x16_bf16 v[72:87], v[156:159], v[20:23], v[72:87]
    v_add_f32 v44, v161, v44
    v_exp_f32 v44, v44
    v_add_f32 v45, v161, v45
    v_exp_f32 v45, v45
    v_cvt_pk_bf16_f32 v17, v42, v43
    v_add_f32 v46, v161, v46
    v_exp_f32 v46, v46
    v_add_f32 v47, v161, v47
    v_exp_f32 v47, v47
    v_cvt_pk_bf16_f32 v18, v44, v45
    v_add_f32 v48, v161, v48
    v_exp_f32 v48, v48
    v_cvt_pk_bf16_f32 v19, v46, v47
    v_add_f32 v49, v161, v49
    v_exp_f32 v49, v49
    v_add_f32 v50, v161, v50
    v_exp_f32 v50, v50
    v_mfma_f32_32x32x16_bf16 v[88:103], v[152:155], v[16:19], v[88:103]
    v_add_f32 v51, v161, v51
    v_exp_f32 v51, v51
    v_cvt_pk_bf16_f32 v20, v48, v49
    v_add_f32 v52, v161, v52
    v_exp_f32 v52, v52
    v_add_f32 v53, v161, v53
    v_exp_f32 v53, v53
    v_cvt_pk_bf16_f32 v21, v50, v51
    v_add_f32 v54, v161, v54
    v_exp_f32 v54, v54
    v_add_f32 v55, v161, v55
    v_exp_f32 v55, v55
    v_cvt_pk_bf16_f32 v22, v52, v53
    s_nop 0
    v_cvt_pk_bf16_f32 v23, v54, v55
    v_mfma_f32_32x32x16_bf16 v[40:55], v[140:143], v[68:71], 0
    v_add_f32 v24, v162, v24
    v_exp_f32 v24, v24
    v_add_f32 v25, v162, v25
    v_exp_f32 v25, v25
    v_add_f32 v26, v162, v26
    v_exp_f32 v26, v26
    v_add_f32 v27, v162, v27
    v_exp_f32 v27, v27
    v_cvt_pk_bf16_f32 v16, v24, v25
    v_mfma_f32_32x32x16_bf16 v[88:103], v[156:159], v[20:23], v[88:103]
    v_add_f32 v28, v162, v28
    v_exp_f32 v28, v28
    v_add_f32 v29, v162, v29
    v_exp_f32 v29, v29
    v_cvt_pk_bf16_f32 v17, v26, v27
    v_add_f32 v30, v162, v30
    v_exp_f32 v30, v30
    v_add_f32 v31, v162, v31
    v_exp_f32 v31, v31
    v_cvt_pk_bf16_f32 v18, v28, v29
    v_add_f32 v32, v162, v32
    v_exp_f32 v32, v32
    v_cvt_pk_bf16_f32 v19, v30, v31
    v_add_f32 v33, v162, v33
    v_exp_f32 v33, v33
    v_add_f32 v34, v162, v34
    v_exp_f32 v34, v34
    v_mfma_f32_32x32x16_bf16 v[104:119], v[152:155], v[16:19], v[104:119]
    v_add_f32 v35, v162, v35
    v_exp_f32 v35, v35
    v_cvt_pk_bf16_f32 v20, v32, v33
    v_add_f32 v36, v162, v36
    v_exp_f32 v36, v36
    v_add_f32 v37, v162, v37
    v_exp_f32 v37, v37
    v_cvt_pk_bf16_f32 v21, v34, v35
    v_add_f32 v38, v162, v38
    v_exp_f32 v38, v38
    v_add_f32 v39, v162, v39
    v_exp_f32 v39, v39
    v_cvt_pk_bf16_f32 v22, v36, v37
    s_nop 0
    v_cvt_pk_bf16_f32 v23, v38, v39
    s_waitcnt vmcnt(2)
    v_mfma_f32_32x32x16_bf16 v[24:39], v[136:139], v[56:59], 0
    v_add_f32 v40, v163, v40
    v_exp_f32 v40, v40
    v_add_f32 v41, v163, v41
    v_exp_f32 v41, v41
    v_add_f32 v42, v163, v42
    v_exp_f32 v42, v42
    v_add_f32 v43, v163, v43
    v_exp_f32 v43, v43
    v_cvt_pk_bf16_f32 v16, v40, v41
    v_mfma_f32_32x32x16_bf16 v[104:119], v[156:159], v[20:23], v[104:119]
    v_add_f32 v44, v163, v44
    v_exp_f32 v44, v44
    v_add_f32 v45, v163, v45
    v_exp_f32 v45, v45
    v_cvt_pk_bf16_f32 v17, v42, v43
    v_add_f32 v46, v163, v46
    v_exp_f32 v46, v46
    v_add_f32 v47, v163, v47
    v_exp_f32 v47, v47
    v_cvt_pk_bf16_f32 v18, v44, v45
    v_add_f32 v48, v163, v48
    v_exp_f32 v48, v48
    v_cvt_pk_bf16_f32 v19, v46, v47
    v_add_f32 v49, v163, v49
    v_exp_f32 v49, v49
    v_add_f32 v50, v163, v50
    v_exp_f32 v50, v50
    v_mfma_f32_32x32x16_bf16 v[120:135], v[152:155], v[16:19], v[120:135]
    v_add_f32 v51, v163, v51
    v_exp_f32 v51, v51
    v_cvt_pk_bf16_f32 v20, v48, v49
    v_add_f32 v52, v163, v52
    v_exp_f32 v52, v52
    v_add_f32 v53, v163, v53
    v_exp_f32 v53, v53
    v_cvt_pk_bf16_f32 v21, v50, v51
    v_add_f32 v54, v163, v54
    v_exp_f32 v54, v54
    v_add_f32 v55, v163, v55
    v_exp_f32 v55, v55
    v_cvt_pk_bf16_f32 v22, v52, v53
    s_add_u32 s59, s59, 1
    s_add_u32 s62, s59, 1
    s_add_u32 s58, s11, s62
    s_and_b32 s58, s58, 15
    s_lshl_b32 s58, s58, 12
    s_add_u32 s55, s56, s58
    buffer_load_dwordx4 v[140:143], v3, s[24:27], s55 offen sc1
    s_cmp_lt_u32 s59, 14
    v_cvt_pk_bf16_f32 v23, v54, v55
    s_cbranch_scc1 L_loops
    v_mfma_f32_32x32x16_bf16 v[40:55], v[136:139], v[60:63], 0
    v_add_f32 v24, v160, v24
    v_exp_f32 v24, v24
    v_add_f32 v25, v160, v25
    v_exp_f32 v25, v25
    v_add_f32 v26, v160, v26
    v_exp_f32 v26, v26
    v_add_f32 v27, v160, v27
    v_exp_f32 v27, v27
    v_cvt_pk_bf16_f32 v16, v24, v25
    v_mfma_f32_32x32x16_bf16 v[120:135], v[156:159], v[20:23], v[120:135]
    v_add_f32 v28, v160, v28
    v_exp_f32 v28, v28
    v_add_f32 v29, v160, v29
    v_exp_f32 v29, v29
    v_cvt_pk_bf16_f32 v17, v26, v27
    v_add_f32 v30, v160, v30
    v_exp_f32 v30, v30
    v_add_f32 v31, v160, v31
    v_exp_f32 v31, v31
    v_cvt_pk_bf16_f32 v18, v28, v29
    v_add_f32 v32, v160, v32
    v_exp_f32 v32, v32
    v_cvt_pk_bf16_f32 v19, v30, v31
    v_add_f32 v33, v160, v33
    v_exp_f32 v33, v33
    s_waitcnt vmcnt(1)
    v_add_f32 v34, v160, v34
    v_exp_f32 v34, v34
    v_mfma_f32_32x32x16_bf16 v[72:87], v[144:147], v[16:19], v[72:87]
    v_add_f32 v35, v160, v35
    v_exp_f32 v35, v35
    v_cvt_pk_bf16_f32 v20, v32, v33
    v_add_f32 v36, v160, v36
    v_exp_f32 v36, v36
    v_add_f32 v37, v160, v37
    v_exp_f32 v37, v37
    v_cvt_pk_bf16_f32 v21, v34, v35
    v_add_f32 v38, v160, v38
    v_exp_f32 v38, v38
    v_add_f32 v39, v160, v39
    v_exp_f32 v39, v39
    v_cvt_pk_bf16_f32 v22, v36, v37
    s_add_u32 s55, s57, s58
    s_mov_b64 exec, s[60:61]
    buffer_load_dwordx4 v[152:155], v12, s[24:27], s55 offen sc1
    buffer_load_dwordx4 v[156:159], v12, s[24:27], s55 offen offset:512 sc1
    s_mov_b64 exec, -1
    v_cvt_pk_bf16_f32 v23, v38, v39
    v_mfma_f32_32x32x16_bf16 v[24:39], v[136:139], v[64:67], 0
    v_add_f32 v40, v161, v40
    v_exp_f32 v40, v40
    v_add_f32 v41, v161, v41
    v_exp_f32 v41, v41
    v_add_f32 v42, v161, v42
    v_exp_f32 v42, v42
    v_add_f32 v43, v161, v43
    v_exp_f32 v43, v43
    v_cvt_pk_bf16_f32 v16, v40, v41
    v_mfma_f32_32x32x16_bf16 v[72:87], v[148:151], v[20:23], v[72:87]
    v_add_f32 v44, v161, v44
    v_exp_f32 v44, v44
    v_add_f32 v45, v161, v45
    v_exp_f32 v45, v45
    v_cvt_pk_bf16_f32 v17, v42, v43
    v_add_f32 v46, v161, v46
    v_exp_f32 v46, v46
    v_add_f32 v47, v161, v47
    v_exp_f32 v47, v47
    v_cvt_pk_bf16_f32 v18, v44, v45
    v_add_f32 v48, v161, v48
    v_exp_f32 v48, v48
    v_cvt_pk_bf16_f32 v19, v46, v47
    v_add_f32 v49, v161, v49
    v_exp_f32 v49, v49
    v_add_f32 v50, v161, v50
    v_exp_f32 v50, v50
    v_mfma_f32_32x32x16_bf16 v[88:103], v[144:147], v[16:19], v[88:103]
    v_add_f32 v51, v161, v51
    v_exp_f32 v51, v51
    v_cvt_pk_bf16_f32 v20, v48, v49
    v_add_f32 v52, v161, v52
    v_exp_f32 v52, v52
    v_add_f32 v53, v161, v53
    v_exp_f32 v53, v53
    v_cvt_pk_bf16_f32 v21, v50, v51
    v_add_f32 v54, v161, v54
    v_exp_f32 v54, v54
    v_add_f32 v55, v161, v55
    v_exp_f32 v55, v55
    v_cvt_pk_bf16_f32 v22, v52, v53
    s_nop 0
    v_cvt_pk_bf16_f32 v23, v54, v55
    v_mfma_f32_32x32x16_bf16 v[40:55], v[136:139], v[68:71], 0
    v_add_f32 v24, v162, v24
    v_exp_f32 v24, v24
    v_add_f32 v25, v162, v25
    v_exp_f32 v25, v25
    v_add_f32 v26, v162, v26
    v_exp_f32 v26, v26
    v_add_f32 v27, v162, v27
    v_exp_f32 v27, v27
    v_cvt_pk_bf16_f32 v16, v24, v25
    v_mfma_f32_32x32x16_bf16 v[88:103], v[148:151], v[20:23], v[88:103]
    v_add_f32 v28, v162, v28
    v_exp_f32 v28, v28
    v_add_f32 v29, v162, v29
    v_exp_f32 v29, v29
    v_cvt_pk_bf16_f32 v17, v26, v27
    v_add_f32 v30, v162, v30
    v_exp_f32 v30, v30
    v_add_f32 v31, v162, v31
    v_exp_f32 v31, v31
    v_cvt_pk_bf16_f32 v18, v28, v29
    v_add_f32 v32, v162, v32
    v_exp_f32 v32, v32
    v_cvt_pk_bf16_f32 v19, v30, v31
    v_add_f32 v33, v162, v33
    v_exp_f32 v33, v33
    v_add_f32 v34, v162, v34
    v_exp_f32 v34, v34
    v_mfma_f32_32x32x16_bf16 v[104:119], v[144:147], v[16:19], v[104:119]
    v_add_f32 v35, v162, v35
    v_exp_f32 v35, v35
    v_cvt_pk_bf16_f32 v20, v32, v33
    v_add_f32 v36, v162, v36
    v_exp_f32 v36, v36
    v_add_f32 v37, v162, v37
    v_exp_f32 v37, v37
    v_cvt_pk_bf16_f32 v21, v34, v35
    v_add_f32 v38, v162, v38
    v_exp_f32 v38, v38
    v_add_f32 v39, v162, v39
    v_exp_f32 v39, v39
    v_cvt_pk_bf16_f32 v22, v36, v37
    s_nop 0
    v_cvt_pk_bf16_f32 v23, v38, v39
    s_waitcnt vmcnt(2)
    v_mfma_f32_32x32x16_bf16 v[24:39], v[140:143], v[56:59], 0
    v_add_f32 v40, v163, v40
    v_exp_f32 v40, v40
    v_add_f32 v41, v163, v41
    v_exp_f32 v41, v41
    v_add_f32 v42, v163, v42
    v_exp_f32 v42, v42
    v_add_f32 v43, v163, v43
    v_exp_f32 v43, v43
    v_cvt_pk_bf16_f32 v16, v40, v41
    v_mfma_f32_32x32x16_bf16 v[104:119], v[148:151], v[20:23], v[104:119]
    v_add_f32 v44, v163, v44
    v_exp_f32 v44, v44
    v_add_f32 v45, v163, v45
    v_exp_f32 v45, v45
    v_cvt_pk_bf16_f32 v17, v42, v43
    v_add_f32 v46, v163, v46
    v_exp_f32 v46, v46
    v_add_f32 v47, v163, v47
    v_exp_f32 v47, v47
    v_cvt_pk_bf16_f32 v18, v44, v45
    v_add_f32 v48, v163, v48
    v_exp_f32 v48, v48
    v_cvt_pk_bf16_f32 v19, v46, v47
    v_add_f32 v49, v163, v49
    v_exp_f32 v49, v49
    v_add_f32 v50, v163, v50
    v_exp_f32 v50, v50
    v_mfma_f32_32x32x16_bf16 v[120:135], v[144:147], v[16:19], v[120:135]
    v_add_f32 v51, v163, v51
    v_exp_f32 v51, v51
    v_cvt_pk_bf16_f32 v20, v48, v49
    v_add_f32 v52, v163, v52
    v_exp_f32 v52, v52
    v_add_f32 v53, v163, v53
    v_exp_f32 v53, v53
    v_cvt_pk_bf16_f32 v21, v50, v51
    v_add_f32 v54, v163, v54
    v_exp_f32 v54, v54
    v_add_f32 v55, v163, v55
    v_exp_f32 v55, v55
    v_cvt_pk_bf16_f32 v22, v52, v53
    s_nop 0
    v_cvt_pk_bf16_f32 v23, v54, v55
    v_mfma_f32_32x32x16_bf16 v[40:55], v[140:143], v[60:63], 0
    v_add_f32 v24, v160, v24
    v_exp_f32 v24, v24
    v_add_f32 v25, v160, v25
    v_exp_f32 v25, v25
    v_add_f32 v26, v160, v26
    v_exp_f32 v26, v26
    v_add_f32 v27, v160, v27
    v_exp_f32 v27, v27
    v_cvt_pk_bf16_f32 v16, v24, v25
    v_mfma_f32_32x32x16_bf16 v[120:135], v[148:151], v[20:23], v[120:135]
    v_add_f32 v28, v160, v28
    v_exp_f32 v28, v28
    v_add_f32 v29, v160, v29
    v_exp_f32 v29, v29
    v_cvt_pk_bf16_f32 v17, v26, v27
    v_add_f32 v30, v160, v30
    v_exp_f32 v30, v30
    v_add_f32 v31, v160, v31
    v_exp_f32 v31, v31
    v_cvt_pk_bf16_f32 v18, v28, v29
    v_add_f32 v32, v160, v32
    v_exp_f32 v32, v32
    v_cvt_pk_bf16_f32 v19, v30, v31
    v_add_f32 v33, v160, v33
    v_exp_f32 v33, v33
    s_waitcnt vmcnt(0)
    v_add_f32 v34, v160, v34
    v_exp_f32 v34, v34
    v_mfma_f32_32x32x16_bf16 v[72:87], v[152:155], v[16:19], v[72:87]
    v_add_f32 v35, v160, v35
    v_exp_f32 v35, v35
    v_cvt_pk_bf16_f32 v20, v32, v33
    v_add_f32 v36, v160, v36
    v_exp_f32 v36, v36
    v_add_f32 v37, v160, v37
    v_exp_f32 v37, v37
    v_cvt_pk_bf16_f32 v21, v34, v35
    v_add_f32 v38, v160, v38
    v_exp_f32 v38, v38
    v_add_f32 v39, v160, v39
    v_exp_f32 v39, v39
    v_cvt_pk_bf16_f32 v22, v36, v37
    s_nop 0
    v_cvt_pk_bf16_f32 v23, v38, v39
    v_mfma_f32_32x32x16_bf16 v[24:39], v[140:143], v[64:67], 0
    v_add_f32 v40, v161, v40
    v_exp_f32 v40, v40
    v_add_f32 v41, v161, v41
    v_exp_f32 v41, v41
    v_add_f32 v42, v161, v42
    v_exp_f32 v42, v42
    v_add_f32 v43, v161, v43
    v_exp_f32 v43, v43
    v_cvt_pk_bf16_f32 v16, v40, v41
    v_mfma_f32_32x32x16_bf16 v[72:87], v[156:159], v[20:23], v[72:87]
    v_add_f32 v44, v161, v44
    v_exp_f32 v44, v44
    v_add_f32 v45, v161, v45
    v_exp_f32 v45, v45
    v_cvt_pk_bf16_f32 v17, v42, v43
    v_add_f32 v46, v161, v46
    v_exp_f32 v46, v46
    v_add_f32 v47, v161, v47
    v_exp_f32 v47, v47
    v_cvt_pk_bf16_f32 v18, v44, v45
    v_add_f32 v48, v161, v48
    v_exp_f32 v48, v48
    v_cvt_pk_bf16_f32 v19, v46, v47
    v_add_f32 v49, v161, v49
    v_exp_f32 v49, v49
    v_add_f32 v50, v161, v50
    v_exp_f32 v50, v50
    v_mfma_f32_32x32x16_bf16 v[88:103], v[152:155], v[16:19], v[88:103]
    v_add_f32 v51, v161, v51
    v_exp_f32 v51, v51
    v_cvt_pk_bf16_f32 v20, v48, v49
    v_add_f32 v52, v161, v52
    v_exp_f32 v52, v52
    v_add_f32 v53, v161, v53
    v_exp_f32 v53, v53
    v_cvt_pk_bf16_f32 v21, v50, v51
    v_add_f32 v54, v161, v54
    v_exp_f32 v54, v54
    v_add_f32 v55, v161, v55
    v_exp_f32 v55, v55
    v_cvt_pk_bf16_f32 v22, v52, v53
    s_nop 0
    v_cvt_pk_bf16_f32 v23, v54, v55
    v_mfma_f32_32x32x16_bf16 v[40:55], v[140:143], v[68:71], 0
    v_add_f32 v24, v162, v24
    v_exp_f32 v24, v24
    v_add_f32 v25, v162, v25
    v_exp_f32 v25, v25
    v_add_f32 v26, v162, v26
    v_exp_f32 v26, v26
    v_add_f32 v27, v162, v27
    v_exp_f32 v27, v27
    v_cvt_pk_bf16_f32 v16, v24, v25
    v_mfma_f32_32x32x16_bf16 v[88:103], v[156:159], v[20:23], v[88:103]
    v_add_f32 v28, v162, v28
    v_exp_f32 v28, v28
    v_add_f32 v29, v162, v29
    v_exp_f32 v29, v29
    v_cvt_pk_bf16_f32 v17, v26, v27
    v_add_f32 v30, v162, v30
    v_exp_f32 v30, v30
    v_add_f32 v31, v162, v31
    v_exp_f32 v31, v31
    v_cvt_pk_bf16_f32 v18, v28, v29
    v_add_f32 v32, v162, v32
    v_exp_f32 v32, v32
    v_cvt_pk_bf16_f32 v19, v30, v31
    v_add_f32 v33, v162, v33
    v_exp_f32 v33, v33
    v_add_f32 v34, v162, v34
    v_exp_f32 v34, v34
    v_mfma_f32_32x32x16_bf16 v[104:119], v[152:155], v[16:19], v[104:119]
    v_add_f32 v35, v162, v35
    v_exp_f32 v35, v35
    v_cvt_pk_bf16_f32 v20, v32, v33
    v_add_f32 v36, v162, v36
    v_exp_f32 v36, v36
    v_add_f32 v37, v162, v37
    v_exp_f32 v37, v37
    v_cvt_pk_bf16_f32 v21, v34, v35
    v_add_f32 v38, v162, v38
    v_exp_f32 v38, v38
    v_add_f32 v39, v162, v39
    v_exp_f32 v39, v39
    v_cvt_pk_bf16_f32 v22, v36, v37
    s_nop 0
    v_cvt_pk_bf16_f32 v23, v38, v39
    v_add_f32 v40, v163, v40
    v_exp_f32 v40, v40
    v_add_f32 v41, v163, v41
    v_exp_f32 v41, v41
    v_add_f32 v42, v163, v42
    v_exp_f32 v42, v42
    v_add_f32 v43, v163, v43
    v_exp_f32 v43, v43
    v_cvt_pk_bf16_f32 v16, v40, v41
    v_mfma_f32_32x32x16_bf16 v[104:119], v[156:159], v[20:23], v[104:119]
    v_add_f32 v44, v163, v44
    v_exp_f32 v44, v44
    v_add_f32 v45, v163, v45
    v_exp_f32 v45, v45
    v_cvt_pk_bf16_f32 v17, v42, v43
    v_add_f32 v46, v163, v46
    v_exp_f32 v46, v46
    v_add_f32 v47, v163, v47
    v_exp_f32 v47, v47
    v_cvt_pk_bf16_f32 v18, v44, v45
    v_add_f32 v48, v163, v48
    v_exp_f32 v48, v48
    v_cvt_pk_bf16_f32 v19, v46, v47
    v_add_f32 v49, v163, v49
    v_exp_f32 v49, v49
    v_add_f32 v50, v163, v50
    v_exp_f32 v50, v50
    v_mfma_f32_32x32x16_bf16 v[120:135], v[152:155], v[16:19], v[120:135]
    v_add_f32 v51, v163, v51
    v_exp_f32 v51, v51
    v_cvt_pk_bf16_f32 v20, v48, v49
    v_add_f32 v52, v163, v52
    v_exp_f32 v52, v52
    v_add_f32 v53, v163, v53
    v_exp_f32 v53, v53
    v_cvt_pk_bf16_f32 v21, v50, v51
    v_add_f32 v54, v163, v54
    v_exp_f32 v54, v54
    v_add_f32 v55, v163, v55
    v_exp_f32 v55, v55
    v_cvt_pk_bf16_f32 v22, v52, v53
    s_nop 0
    v_cvt_pk_bf16_f32 v23, v54, v55
    s_nop 1
    v_mfma_f32_32x32x16_bf16 v[120:135], v[156:159], v[20:23], v[120:135]
L_attn_fin:
    s_mul_i32 s56, s13, 27648
    s_add_u32 s56, s56, 65536
    v_lshlrev_b32 v11, 2, v1
    v_cmp_lt_u32 vcc, 31, v1
    s_nop 7
    s_nop 3
    v_cndmask_b32 v80, v80, v160, vcc
    s_cmp_eq_u32 s14, 0
    s_cbranch_scc1 L_cown_33
    s_sub_u32 s54, s14, 1
    s_and_b32 s54, s54, 3
    s_mul_i32 s54, s54, 2304
    s_add_u32 s54, s54, s56
    v_add_u32 v6, s54, v3
    v_add_u32 v7, s54, v11
    ds_write_b128 v6, v[72:75] offset:0
    ds_write_b128 v6, v[76:79] offset:1024
    ds_write_b32 v7, v80 offset:2048
    s_branch L_cnx_34
L_cown_33:
    v_mov_b32 v24, v72
    v_mov_b32 v25, v73
    v_mov_b32 v26, v74
    v_mov_b32 v27, v75
    v_mov_b32 v28, v76
    v_mov_b32 v29, v77
    v_mov_b32 v30, v78
    v_mov_b32 v31, v79
    v_mov_b32 v32, v80
L_cnx_34:
    v_cndmask_b32 v96, v96, v161, vcc
    s_cmp_eq_u32 s14, 1
    s_cbranch_scc1 L_cown_35
    s_sub_u32 s54, s14, 2
    s_and_b32 s54, s54, 3
    s_mul_i32 s54, s54, 2304
    s_add_u32 s54, s54, s56
    v_add_u32 v6, s54, v3
    v_add_u32 v7, s54, v11
    ds_write_b128 v6, v[88:91] offset:6912
    ds_write_b128 v6, v[92:95] offset:7936
    ds_write_b32 v7, v96 offset:8960
    s_branch L_cnx_36
L_cown_35:
    v_mov_b32 v24, v88
    v_mov_b32 v25, v89
    v_mov_b32 v26, v90
    v_mov_b32 v27, v91
    v_mov_b32 v28, v92
    v_mov_b32 v29, v93
    v_mov_b32 v30, v94
    v_mov_b32 v31, v95
    v_mov_b32 v32, v96
L_cnx_36:
    v_cndmask_b32 v112, v112, v162, vcc
    s_cmp_eq_u32 s14, 2
    s_cbranch_scc1 L_cown_37
    s_sub_u32 s54, s14, 3
    s_and_b32 s54, s54, 3
    s_mul_i32 s54, s54, 2304
    s_add_u32 s54, s54, s56
    v_add_u32 v6, s54, v3
    v_add_u32 v7, s54, v11
    ds_write_b128 v6, v[104:107] offset:13824
    ds_write_b128 v6, v[108:111] offset:14848
    ds_write_b32 v7, v112 offset:15872
    s_branch L_cnx_38
L_cown_37:
    v_mov_b32 v24, v104
    v_mov_b32 v25, v105
    v_mov_b32 v26, v106
    v_mov_b32 v27, v107
    v_mov_b32 v28, v108
    v_mov_b32 v29, v109
    v_mov_b32 v30, v110
    v_mov_b32 v31, v111
    v_mov_b32 v32, v112
L_cnx_38:
    v_cndmask_b32 v128, v128, v163, vcc
    s_cmp_eq_u32 s14, 3
    s_cbranch_scc1 L_cown_39
    s_sub_u32 s54, s14, 4
    s_and_b32 s54, s54, 3
    s_mul_i32 s54, s54, 2304
    s_add_u32 s54, s54, s56
    v_add_u32 v6, s54, v3
    v_add_u32 v7, s54, v11
    ds_write_b128 v6, v[120:123] offset:20736
    ds_write_b128 v6, v[124:127] offset:21760
    ds_write_b32 v7, v128 offset:22784
    s_branch L_cnx_40
L_cown_39:
    v_mov_b32 v24, v120
    v_mov_b32 v25, v121
    v_mov_b32 v26, v122
    v_mov_b32 v27, v123
    v_mov_b32 v28, v124
    v_mov_b32 v29, v125
    v_mov_b32 v30, v126
    v_mov_b32 v31, v127
    v_mov_b32 v32, v128
L_cnx_40:
    s_mul_i32 s54, s14, 6912
    s_add_u32 s56, s56, s54
    v_add_u32 v6, s56, v3
    v_add_u32 v7, s56, v11
    s_waitcnt lgkmcnt(0)
    s_barrier
    ds_read_b128 v[36:39], v6 offset:0
    ds_read_b128 v[40:43], v6 offset:1024
    ds_read_b32 v44, v7 offset:2048
    ds_read_b128 v[48:51], v6 offset:2304
    ds_read_b128 v[52:55], v6 offset:3328
    ds_read_b32 v56, v7 offset:4352
    ds_read_b128 v[60:63], v6 offset:4608
    ds_read_b128 v[64:67], v6 offset:5632
    ds_read_b32 v68, v7 offset:6656
    s_waitcnt lgkmcnt(0)
    v_mov_b32 v33, v32
    v_mov_b32 v45, v44
    v_mov_b32 v57, v56
    v_mov_b32 v69, v68
    s_nop 1
    v_permlane32_swap_b32 v32, v33
    v_permlane32_swap_b32 v44, v45
    v_permlane32_swap_b32 v56, v57
    v_permlane32_swap_b32 v68, v69
    v_min_f32 v6, v33, v45
    v_min3_f32 v6, v57, v69, v6
    v_sub_f32 v33, v6, v33
    v_sub_f32 v45, v6, v45
    v_sub_f32 v57, v6, v57
    v_sub_f32 v69, v6, v69
    v_exp_f32 v33, v33
    v_exp_f32 v45, v45
    v_exp_f32 v57, v57
    v_exp_f32 v69, v69
    s_nop 0
    v_mul_f32 v32, v33, v32
    v_fmac_f32 v32, v45, v44
    v_fmac_f32 v32, v57, v56
    v_fmac_f32 v32, v69, v68
    v_rcp_f32 v6, v32
    v_mul_f32 v24, v33, v24
    v_fmac_f32 v24, v45, v36
    v_fmac_f32 v24, v57, v48
    v_fmac_f32 v24, v69, v60
    v_mul_f32 v25, v33, v25
    v_fmac_f32 v25, v45, v37
    v_fmac_f32 v25, v57, v49
    v_fmac_f32 v25, v69, v61
    v_mul_f32 v26, v33, v26
    v_fmac_f32 v26, v45, v38
    v_fmac_f32 v26, v57, v50
    v_fmac_f32 v26, v69, v62
    v_mul_f32 v27, v33, v27
    v_fmac_f32 v27, v45, v39
    v_fmac_f32 v27, v57, v51
    v_fmac_f32 v27, v69, v63
    v_mul_f32 v28, v33, v28
    v_fmac_f32 v28, v45, v40
    v_fmac_f32 v28, v57, v52
    v_fmac_f32 v28, v69, v64
    v_mul_f32 v29, v33, v29
    v_fmac_f32 v29, v45, v41
    v_fmac_f32 v29, v57, v53
    v_fmac_f32 v29, v69, v65
    v_mul_f32 v30, v33, v30
    v_fmac_f32 v30, v45, v42
    v_fmac_f32 v30, v57, v54
    v_fmac_f32 v30, v69, v66
    v_mul_f32 v31, v33, v31
    v_fmac_f32 v31, v45, v43
    v_fmac_f32 v31, v57, v55
    v_fmac_f32 v31, v69, v67
    v_mul_f32 v24, v6, v24
    v_mul_f32 v25, v6, v25
    v_mul_f32 v26, v6, v26
    v_mul_f32 v27, v6, v27
    v_mul_f32 v28, v6, v28
    v_mul_f32 v29, v6, v29
    v_mul_f32 v30, v6, v30
    v_mul_f32 v31, v6, v31
    v_cvt_pk_bf16_f32 v16, v24, v25
    v_cvt_pk_bf16_f32 v17, v26, v27
    v_cvt_pk_bf16_f32 v18, v28, v29
    v_cvt_pk_bf16_f32 v19, v30, v31
    v_and_b32 v6, 1, v5
    v_lshlrev_b32 v6, 14, v6
    v_lshl_add_u32 v6, v13, 8, v6
    v_lshl_add_u32 v6, v4, 4, v6
    s_lshl_b32 s54, s11, 2
    s_add_u32 s54, s54, s14
    s_lshl_b32 s55, s54, 15
    s_lshl_b32 s62, s10, 10
    s_add_u32 s55, s55, s62
    s_lshl_b32 s62, s13, 9
    s_add_u32 s55, s55, s62
    s_add_u32 s55, s55, 4194304
    buffer_store_dwordx4 v[16:19], v6, s[24:27], s55 offen sc1
    s_barrier
    s_cmp_ge_u32 s12, 4
    s_cbranch_scc1 L_team
    s_mov_b32 s15, s56
    s_and_b32 s54, s2, 7
    s_lshl_b32 s54, s54, 2
    s_bfe_u32 s56, s2, 0x20003
    s_add_u32 s56, s56, s54
    s_lshl_b32 s56, s56, 2
    s_add_u32 s56, s56, s12
    s_lshr_b32 s57, s2, 5
    s_lshl_b32 s58, s56, 14
    s_add_u32 s62, s58, 4194304
    s_add_u32 s63, s62, 4096
    s_add_u32 s60, s62, 8192
    s_add_u32 s61, s62, 12288
    s_mov_b32 s59, 0xffff
    buffer_load_dwordx4 v[64:67], v3, s[24:27], s62 offen offset:0 sc1
    buffer_load_dwordx4 v[68:71], v3, s[24:27], s62 offen offset:1024 sc1
    buffer_load_dwordx4 v[72:75], v3, s[24:27], s62 offen offset:2048 sc1
    buffer_load_dwordx4 v[76:79], v3, s[24:27], s62 offen offset:3072 sc1
    buffer_load_dwordx4 v[80:83], v3, s[24:27], s63 offen offset:0 sc1
    buffer_load_dwordx4 v[84:87], v3, s[24:27], s63 offen offset:1024 sc1
    buffer_load_dwordx4 v[88:91], v3, s[24:27], s63 offen offset:2048 sc1
    buffer_load_dwordx4 v[92:95], v3, s[24:27], s63 offen offset:3072 sc1
    buffer_load_dwordx4 v[96:99], v3, s[24:27], s60 offen offset:0 sc1
    buffer_load_dwordx4 v[100:103], v3, s[24:27], s60 offen offset:1024 sc1
    buffer_load_dwordx4 v[104:107], v3, s[24:27], s60 offen offset:2048 sc1
    buffer_load_dwordx4 v[108:111], v3, s[24:27], s60 offen offset:3072 sc1
    buffer_load_dwordx4 v[112:115], v3, s[24:27], s61 offen offset:0 sc1
    buffer_load_dwordx4 v[116:119], v3, s[24:27], s61 offen offset:1024 sc1
    buffer_load_dwordx4 v[120:123], v3, s[24:27], s61 offen offset:2048 sc1
    buffer_load_dwordx4 v[124:127], v3, s[24:27], s61 offen offset:3072 sc1
    s_lshl_b32 s54, s57, 7
    s_add_u32 s58, s58, s54
    s_add_u32 s3, s58, 8192
    v_lshlrev_b32 v11, 3, v5
    v_lshl_add_u32 v10, v4, 10, v11
    s_mov_b32 s32, s44
    s_and_b32 s33, s45, 0xffff
    s_mov_b32 s34, 1024
    s_mov_b32 s35, 0x00020000
    v_mov_b32 v164, v10
    v_mov_b32 v6, 162864
    ds_read_b32 v9, v6
    v_lshrrev_b32 v6, 2, v1
    v_and_b32 v7, 3, v1
    v_lshlrev_b32 v8, 7, v6
    v_lshl_add_u32 v8, v7, 3, v8
    v_bfe_u32 v7, v6, 1, 2
    v_lshl_add_u32 v160, v7, 5, v8
    v_xor_b32 v161, 32, v160
    v_xor_b32 v162, 64, v160
    v_xor_b32 v163, 0x60, v160
    v_lshrrev_b32 v14, 3, v1
    v_and_b32 v15, 7, v1
    v_lshlrev_b32 v15, 4, v15
    v_mul_u32_u24 v12, 144, v4
    v_add3_u32 v12, v12, v11, s15
    v_mul_u32_u24 v13, 144, v14
    v_add3_u32 v13, v13, v15, s15
    v_lshl_add_u32 v10, v14, 10, v15
    s_waitcnt lgkmcnt(0)
    v_readfirstlane_b32 s13, v9
    ds_read_b64_tr_b16 v[128:129], v160 offset:0
    ds_read_b64_tr_b16 v[130:131], v160 offset:2048
    ds_read_b64_tr_b16 v[132:133], v161 offset:0
    ds_read_b64_tr_b16 v[134:135], v161 offset:2048
    ds_read_b64_tr_b16 v[136:137], v162 offset:0
    ds_read_b64_tr_b16 v[138:139], v162 offset:2048
    ds_read_b64_tr_b16 v[140:141], v163 offset:0
    ds_read_b64_tr_b16 v[142:143], v163 offset:2048
    s_branch L_poc_43
L_po_41:
    s_cmp_eq_u32 s53, 0
    s_cbranch_scc1 L_poo_42
    s_sub_u32 s53, s53, 1
    s_bitcmp1_b32 s59, 0
    s_cbranch_scc0 L_pk_44
    buffer_load_dwordx4 v[64:67], v3, s[24:27], s62 offen offset:0 sc1
L_pk_44:
    s_bitcmp1_b32 s59, 1
    s_cbranch_scc0 L_pk_45
    buffer_load_dwordx4 v[68:71], v3, s[24:27], s62 offen offset:1024 sc1
L_pk_45:
    s_bitcmp1_b32 s59, 2
    s_cbranch_scc0 L_pk_46
    buffer_load_dwordx4 v[72:75], v3, s[24:27], s62 offen offset:2048 sc1
L_pk_46:
    s_bitcmp1_b32 s59, 3
    s_cbranch_scc0 L_pk_47
    buffer_load_dwordx4 v[76:79], v3, s[24:27], s62 offen offset:3072 sc1
L_pk_47:
    s_bitcmp1_b32 s59, 4
    s_cbranch_scc0 L_pk_48
    buffer_load_dwordx4 v[80:83], v3, s[24:27], s63 offen offset:0 sc1
L_pk_48:
    s_bitcmp1_b32 s59, 5
    s_cbranch_scc0 L_pk_49
    buffer_load_dwordx4 v[84:87], v3, s[24:27], s63 offen offset:1024 sc1
L_pk_49:
    s_bitcmp1_b32 s59, 6
    s_cbranch_scc0 L_pk_50
    buffer_load_dwordx4 v[88:91], v3, s[24:27], s63 offen offset:2048 sc1
L_pk_50:
    s_bitcmp1_b32 s59, 7
    s_cbranch_scc0 L_pk_51
    buffer_load_dwordx4 v[92:95], v3, s[24:27], s63 offen offset:3072 sc1
L_pk_51:
    s_bitcmp1_b32 s59, 8
    s_cbranch_scc0 L_pk_52
    buffer_load_dwordx4 v[96:99], v3, s[24:27], s60 offen offset:0 sc1
L_pk_52:
    s_bitcmp1_b32 s59, 9
    s_cbranch_scc0 L_pk_53
    buffer_load_dwordx4 v[100:103], v3, s[24:27], s60 offen offset:1024 sc1
L_pk_53:
    s_bitcmp1_b32 s59, 10
    s_cbranch_scc0 L_pk_54
    buffer_load_dwordx4 v[104:107], v3, s[24:27], s60 offen offset:2048 sc1
L_pk_54:
    s_bitcmp1_b32 s59, 11
    s_cbranch_scc0 L_pk_55
    buffer_load_dwordx4 v[108:111], v3, s[24:27], s60 offen offset:3072 sc1
L_pk_55:
    s_bitcmp1_b32 s59, 12
    s_cbranch_scc0 L_pk_56
    buffer_load_dwordx4 v[112:115], v3, s[24:27], s61 offen offset:0 sc1
L_pk_56:
    s_bitcmp1_b32 s59, 13
    s_cbranch_scc0 L_pk_57
    buffer_load_dwordx4 v[116:119], v3, s[24:27], s61 offen offset:1024 sc1
L_pk_57:
    s_bitcmp1_b32 s59, 14
    s_cbranch_scc0 L_pk_58
    buffer_load_dwordx4 v[120:123], v3, s[24:27], s61 offen offset:2048 sc1
L_pk_58:
    s_bitcmp1_b32 s59, 15
    s_cbranch_scc0 L_pk_59
    buffer_load_dwordx4 v[124:127], v3, s[24:27], s61 offen offset:3072 sc1
L_pk_59:
L_poc_43:
    s_waitcnt vmcnt(0)
    v_max3_u32 v6, v64, v68, v72
    v_max3_u32 v6, v76, v80, v6
    v_max3_u32 v6, v84, v88, v6
    v_max3_u32 v6, v92, v96, v6
    v_max3_u32 v6, v100, v104, v6
    v_max3_u32 v6, v108, v112, v6
    v_max3_u32 v6, v116, v120, v6
    v_max_u32 v6, v124, v6
    v_cmp_eq_u32 vcc, -1, v6
    s_cmp_eq_u64 vcc, 0
    s_cbranch_scc1 L_poo_42
    s_mov_b32 s59, 0
    v_cmp_eq_u32 vcc, -1, v64
    s_cmp_lg_u64 vcc, 0
    s_cselect_b32 s54, 1, 0
    s_or_b32 s59, s59, s54
    v_cmp_eq_u32 vcc, -1, v68
    s_cmp_lg_u64 vcc, 0
    s_cselect_b32 s54, 2, 0
    s_or_b32 s59, s59, s54
    v_cmp_eq_u32 vcc, -1, v72
    s_cmp_lg_u64 vcc, 0
    s_cselect_b32 s54, 4, 0
    s_or_b32 s59, s59, s54
    v_cmp_eq_u32 vcc, -1, v76
    s_cmp_lg_u64 vcc, 0
    s_cselect_b32 s54, 8, 0
    s_or_b32 s59, s59, s54
    v_cmp_eq_u32 vcc, -1, v80
    s_cmp_lg_u64 vcc, 0
    s_cselect_b32 s54, 16, 0
    s_or_b32 s59, s59, s54
    v_cmp_eq_u32 vcc, -1, v84
    s_cmp_lg_u64 vcc, 0
    s_cselect_b32 s54, 32, 0
    s_or_b32 s59, s59, s54
    v_cmp_eq_u32 vcc, -1, v88
    s_cmp_lg_u64 vcc, 0
    s_cselect_b32 s54, 64, 0
    s_or_b32 s59, s59, s54
    v_cmp_eq_u32 vcc, -1, v92
    s_cmp_lg_u64 vcc, 0
    s_cselect_b32 s54, 128, 0
    s_or_b32 s59, s59, s54
    v_cmp_eq_u32 vcc, -1, v96
    s_cmp_lg_u64 vcc, 0
    s_cselect_b32 s54, 256, 0
    s_or_b32 s59, s59, s54
    v_cmp_eq_u32 vcc, -1, v100
    s_cmp_lg_u64 vcc, 0
    s_cselect_b32 s54, 512, 0
    s_or_b32 s59, s59, s54
    v_cmp_eq_u32 vcc, -1, v104
    s_cmp_lg_u64 vcc, 0
    s_cselect_b32 s54, 1024, 0
    s_or_b32 s59, s59, s54
    v_cmp_eq_u32 vcc, -1, v108
    s_cmp_lg_u64 vcc, 0
    s_cselect_b32 s54, 2048, 0
    s_or_b32 s59, s59, s54
    v_cmp_eq_u32 vcc, -1, v112
    s_cmp_lg_u64 vcc, 0
    s_cselect_b32 s54, 4096, 0
    s_or_b32 s59, s59, s54
    v_cmp_eq_u32 vcc, -1, v116
    s_cmp_lg_u64 vcc, 0
    s_cselect_b32 s54, 8192, 0
    s_or_b32 s59, s59, s54
    v_cmp_eq_u32 vcc, -1, v120
    s_cmp_lg_u64 vcc, 0
    s_cselect_b32 s54, 16384, 0
    s_or_b32 s59, s59, s54
    v_cmp_eq_u32 vcc, -1, v124
    s_cmp_lg_u64 vcc, 0
    s_cselect_b32 s54, 32768, 0
    s_or_b32 s59, s59, s54
    s_sleep 2
    s_branch L_po_41
L_poo_42:
    s_lshl_b32 s54, s57, 7
    buffer_load_dwordx2 v[32:33], v164, s[16:19], s58 offen offset:0
    buffer_load_dwordx2 v[40:41], v11, s[32:35], s54 offen offset:0
    buffer_load_dwordx2 v[34:35], v164, s[16:19], s58 offen offset:32
    buffer_load_dwordx2 v[42:43], v11, s[32:35], s54 offen offset:32
    buffer_load_dwordx2 v[36:37], v164, s[16:19], s58 offen offset:64
    buffer_load_dwordx2 v[44:45], v11, s[32:35], s54 offen offset:64
    buffer_load_dwordx2 v[38:39], v164, s[16:19], s58 offen offset:96
    buffer_load_dwordx2 v[46:47], v11, s[32:35], s54 offen offset:96
    buffer_load_dwordx4 v[56:59], v3, s[32:35], 0 offen
    ds_read_b64_tr_b16 v[144:145], v160 offset:4096
    ds_read_b64_tr_b16 v[146:147], v160 offset:6144
    ds_read_b64_tr_b16 v[148:149], v161 offset:4096
    ds_read_b64_tr_b16 v[150:151], v161 offset:6144
    ds_read_b64_tr_b16 v[152:153], v162 offset:4096
    ds_read_b64_tr_b16 v[154:155], v162 offset:6144
    ds_read_b64_tr_b16 v[156:157], v163 offset:4096
    ds_read_b64_tr_b16 v[158:159], v163 offset:6144
    s_waitcnt lgkmcnt(8)
    v_mfma_f32_16x16x32_bf16 v[16:19], v[128:131], v[64:67], 0
    v_mfma_f32_16x16x32_bf16 v[20:23], v[132:135], v[64:67], 0
    v_mfma_f32_16x16x32_bf16 v[24:27], v[136:139], v[64:67], 0
    v_mfma_f32_16x16x32_bf16 v[28:31], v[140:143], v[64:67], 0
    ds_read_b64_tr_b16 v[128:129], v160 offset:8192
    ds_read_b64_tr_b16 v[130:131], v160 offset:10240
    ds_read_b64_tr_b16 v[132:133], v161 offset:8192
    ds_read_b64_tr_b16 v[134:135], v161 offset:10240
    ds_read_b64_tr_b16 v[136:137], v162 offset:8192
    ds_read_b64_tr_b16 v[138:139], v162 offset:10240
    ds_read_b64_tr_b16 v[140:141], v163 offset:8192
    ds_read_b64_tr_b16 v[142:143], v163 offset:10240
    s_waitcnt lgkmcnt(8)
    v_mfma_f32_16x16x32_bf16 v[16:19], v[144:147], v[68:71], v[16:19]
    v_mfma_f32_16x16x32_bf16 v[20:23], v[148:151], v[68:71], v[20:23]
    v_mfma_f32_16x16x32_bf16 v[24:27], v[152:155], v[68:71], v[24:27]
    v_mfma_f32_16x16x32_bf16 v[28:31], v[156:159], v[68:71], v[28:31]
    ds_read_b64_tr_b16 v[144:145], v160 offset:12288
    ds_read_b64_tr_b16 v[146:147], v160 offset:14336
    ds_read_b64_tr_b16 v[148:149], v161 offset:12288
    ds_read_b64_tr_b16 v[150:151], v161 offset:14336
    ds_read_b64_tr_b16 v[152:153], v162 offset:12288
    ds_read_b64_tr_b16 v[154:155], v162 offset:14336
    ds_read_b64_tr_b16 v[156:157], v163 offset:12288
    ds_read_b64_tr_b16 v[158:159], v163 offset:14336
    s_waitcnt lgkmcnt(8)
    v_mfma_f32_16x16x32_bf16 v[16:19], v[128:131], v[72:75], v[16:19]
    v_mfma_f32_16x16x32_bf16 v[20:23], v[132:135], v[72:75], v[20:23]
    v_mfma_f32_16x16x32_bf16 v[24:27], v[136:139], v[72:75], v[24:27]
    v_mfma_f32_16x16x32_bf16 v[28:31], v[140:143], v[72:75], v[28:31]
    ds_read_b64_tr_b16 v[128:129], v160 offset:16384
    ds_read_b64_tr_b16 v[130:131], v160 offset:18432
    ds_read_b64_tr_b16 v[132:133], v161 offset:16384
    ds_read_b64_tr_b16 v[134:135], v161 offset:18432
    ds_read_b64_tr_b16 v[136:137], v162 offset:16384
    ds_read_b64_tr_b16 v[138:139], v162 offset:18432
    ds_read_b64_tr_b16 v[140:141], v163 offset:16384
    ds_read_b64_tr_b16 v[142:143], v163 offset:18432
    s_waitcnt lgkmcnt(8)
    v_mfma_f32_16x16x32_bf16 v[16:19], v[144:147], v[76:79], v[16:19]
    v_mfma_f32_16x16x32_bf16 v[20:23], v[148:151], v[76:79], v[20:23]
    v_mfma_f32_16x16x32_bf16 v[24:27], v[152:155], v[76:79], v[24:27]
    v_mfma_f32_16x16x32_bf16 v[28:31], v[156:159], v[76:79], v[28:31]
    ds_read_b64_tr_b16 v[144:145], v160 offset:20480
    ds_read_b64_tr_b16 v[146:147], v160 offset:22528
    ds_read_b64_tr_b16 v[148:149], v161 offset:20480
    ds_read_b64_tr_b16 v[150:151], v161 offset:22528
    ds_read_b64_tr_b16 v[152:153], v162 offset:20480
    ds_read_b64_tr_b16 v[154:155], v162 offset:22528
    ds_read_b64_tr_b16 v[156:157], v163 offset:20480
    ds_read_b64_tr_b16 v[158:159], v163 offset:22528
    s_waitcnt lgkmcnt(8)
    v_mfma_f32_16x16x32_bf16 v[16:19], v[128:131], v[80:83], v[16:19]
    v_mfma_f32_16x16x32_bf16 v[20:23], v[132:135], v[80:83], v[20:23]
    v_mfma_f32_16x16x32_bf16 v[24:27], v[136:139], v[80:83], v[24:27]
    v_mfma_f32_16x16x32_bf16 v[28:31], v[140:143], v[80:83], v[28:31]
    ds_read_b64_tr_b16 v[128:129], v160 offset:24576
    ds_read_b64_tr_b16 v[130:131], v160 offset:26624
    ds_read_b64_tr_b16 v[132:133], v161 offset:24576
    ds_read_b64_tr_b16 v[134:135], v161 offset:26624
    ds_read_b64_tr_b16 v[136:137], v162 offset:24576
    ds_read_b64_tr_b16 v[138:139], v162 offset:26624
    ds_read_b64_tr_b16 v[140:141], v163 offset:24576
    ds_read_b64_tr_b16 v[142:143], v163 offset:26624
    s_waitcnt lgkmcnt(8)
    v_mfma_f32_16x16x32_bf16 v[16:19], v[144:147], v[84:87], v[16:19]
    v_mfma_f32_16x16x32_bf16 v[20:23], v[148:151], v[84:87], v[20:23]
    v_mfma_f32_16x16x32_bf16 v[24:27], v[152:155], v[84:87], v[24:27]
    v_mfma_f32_16x16x32_bf16 v[28:31], v[156:159], v[84:87], v[28:31]
    ds_read_b64_tr_b16 v[144:145], v160 offset:28672
    ds_read_b64_tr_b16 v[146:147], v160 offset:30720
    ds_read_b64_tr_b16 v[148:149], v161 offset:28672
    ds_read_b64_tr_b16 v[150:151], v161 offset:30720
    ds_read_b64_tr_b16 v[152:153], v162 offset:28672
    ds_read_b64_tr_b16 v[154:155], v162 offset:30720
    ds_read_b64_tr_b16 v[156:157], v163 offset:28672
    ds_read_b64_tr_b16 v[158:159], v163 offset:30720
    s_waitcnt lgkmcnt(8)
    v_mfma_f32_16x16x32_bf16 v[16:19], v[128:131], v[88:91], v[16:19]
    v_mfma_f32_16x16x32_bf16 v[20:23], v[132:135], v[88:91], v[20:23]
    v_mfma_f32_16x16x32_bf16 v[24:27], v[136:139], v[88:91], v[24:27]
    v_mfma_f32_16x16x32_bf16 v[28:31], v[140:143], v[88:91], v[28:31]
    ds_read_b64_tr_b16 v[128:129], v160 offset:32768
    ds_read_b64_tr_b16 v[130:131], v160 offset:34816
    ds_read_b64_tr_b16 v[132:133], v161 offset:32768
    ds_read_b64_tr_b16 v[134:135], v161 offset:34816
    ds_read_b64_tr_b16 v[136:137], v162 offset:32768
    ds_read_b64_tr_b16 v[138:139], v162 offset:34816
    ds_read_b64_tr_b16 v[140:141], v163 offset:32768
    ds_read_b64_tr_b16 v[142:143], v163 offset:34816
    s_waitcnt lgkmcnt(8)
    v_mfma_f32_16x16x32_bf16 v[16:19], v[144:147], v[92:95], v[16:19]
    v_mfma_f32_16x16x32_bf16 v[20:23], v[148:151], v[92:95], v[20:23]
    v_mfma_f32_16x16x32_bf16 v[24:27], v[152:155], v[92:95], v[24:27]
    v_mfma_f32_16x16x32_bf16 v[28:31], v[156:159], v[92:95], v[28:31]
    ds_read_b64_tr_b16 v[144:145], v160 offset:36864
    ds_read_b64_tr_b16 v[146:147], v160 offset:38912
    ds_read_b64_tr_b16 v[148:149], v161 offset:36864
    ds_read_b64_tr_b16 v[150:151], v161 offset:38912
    ds_read_b64_tr_b16 v[152:153], v162 offset:36864
    ds_read_b64_tr_b16 v[154:155], v162 offset:38912
    ds_read_b64_tr_b16 v[156:157], v163 offset:36864
    ds_read_b64_tr_b16 v[158:159], v163 offset:38912
    s_waitcnt lgkmcnt(8)
    v_mfma_f32_16x16x32_bf16 v[16:19], v[128:131], v[96:99], v[16:19]
    v_mfma_f32_16x16x32_bf16 v[20:23], v[132:135], v[96:99], v[20:23]
    v_mfma_f32_16x16x32_bf16 v[24:27], v[136:139], v[96:99], v[24:27]
    v_mfma_f32_16x16x32_bf16 v[28:31], v[140:143], v[96:99], v[28:31]
    ds_read_b64_tr_b16 v[128:129], v160 offset:40960
    ds_read_b64_tr_b16 v[130:131], v160 offset:43008
    ds_read_b64_tr_b16 v[132:133], v161 offset:40960
    ds_read_b64_tr_b16 v[134:135], v161 offset:43008
    ds_read_b64_tr_b16 v[136:137], v162 offset:40960
    ds_read_b64_tr_b16 v[138:139], v162 offset:43008
    ds_read_b64_tr_b16 v[140:141], v163 offset:40960
    ds_read_b64_tr_b16 v[142:143], v163 offset:43008
    s_waitcnt lgkmcnt(8)
    v_mfma_f32_16x16x32_bf16 v[16:19], v[144:147], v[100:103], v[16:19]
    v_mfma_f32_16x16x32_bf16 v[20:23], v[148:151], v[100:103], v[20:23]
    v_mfma_f32_16x16x32_bf16 v[24:27], v[152:155], v[100:103], v[24:27]
    v_mfma_f32_16x16x32_bf16 v[28:31], v[156:159], v[100:103], v[28:31]
    ds_read_b64_tr_b16 v[144:145], v160 offset:45056
    ds_read_b64_tr_b16 v[146:147], v160 offset:47104
    ds_read_b64_tr_b16 v[148:149], v161 offset:45056
    ds_read_b64_tr_b16 v[150:151], v161 offset:47104
    ds_read_b64_tr_b16 v[152:153], v162 offset:45056
    ds_read_b64_tr_b16 v[154:155], v162 offset:47104
    ds_read_b64_tr_b16 v[156:157], v163 offset:45056
    ds_read_b64_tr_b16 v[158:159], v163 offset:47104
    s_waitcnt lgkmcnt(8)
    v_mfma_f32_16x16x32_bf16 v[16:19], v[128:131], v[104:107], v[16:19]
    v_mfma_f32_16x16x32_bf16 v[20:23], v[132:135], v[104:107], v[20:23]
    v_mfma_f32_16x16x32_bf16 v[24:27], v[136:139], v[104:107], v[24:27]
    v_mfma_f32_16x16x32_bf16 v[28:31], v[140:143], v[104:107], v[28:31]
    ds_read_b64_tr_b16 v[128:129], v160 offset:49152
    ds_read_b64_tr_b16 v[130:131], v160 offset:51200
    ds_read_b64_tr_b16 v[132:133], v161 offset:49152
    ds_read_b64_tr_b16 v[134:135], v161 offset:51200
    ds_read_b64_tr_b16 v[136:137], v162 offset:49152
    ds_read_b64_tr_b16 v[138:139], v162 offset:51200
    ds_read_b64_tr_b16 v[140:141], v163 offset:49152
    ds_read_b64_tr_b16 v[142:143], v163 offset:51200
    s_waitcnt lgkmcnt(8)
    v_mfma_f32_16x16x32_bf16 v[16:19], v[144:147], v[108:111], v[16:19]
    v_mfma_f32_16x16x32_bf16 v[20:23], v[148:151], v[108:111], v[20:23]
    v_mfma_f32_16x16x32_bf16 v[24:27], v[152:155], v[108:111], v[24:27]
    v_mfma_f32_16x16x32_bf16 v[28:31], v[156:159], v[108:111], v[28:31]
    ds_read_b64_tr_b16 v[144:145], v160 offset:53248
    ds_read_b64_tr_b16 v[146:147], v160 offset:55296
    ds_read_b64_tr_b16 v[148:149], v161 offset:53248
    ds_read_b64_tr_b16 v[150:151], v161 offset:55296
    ds_read_b64_tr_b16 v[152:153], v162 offset:53248
    ds_read_b64_tr_b16 v[154:155], v162 offset:55296
    ds_read_b64_tr_b16 v[156:157], v163 offset:53248
    ds_read_b64_tr_b16 v[158:159], v163 offset:55296
    s_waitcnt lgkmcnt(8)
    v_mfma_f32_16x16x32_bf16 v[16:19], v[128:131], v[112:115], v[16:19]
    v_mfma_f32_16x16x32_bf16 v[20:23], v[132:135], v[112:115], v[20:23]
    v_mfma_f32_16x16x32_bf16 v[24:27], v[136:139], v[112:115], v[24:27]
    v_mfma_f32_16x16x32_bf16 v[28:31], v[140:143], v[112:115], v[28:31]
    ds_read_b64_tr_b16 v[128:129], v160 offset:57344
    ds_read_b64_tr_b16 v[130:131], v160 offset:59392
    ds_read_b64_tr_b16 v[132:133], v161 offset:57344
    ds_read_b64_tr_b16 v[134:135], v161 offset:59392
    ds_read_b64_tr_b16 v[136:137], v162 offset:57344
    ds_read_b64_tr_b16 v[138:139], v162 offset:59392
    ds_read_b64_tr_b16 v[140:141], v163 offset:57344
    ds_read_b64_tr_b16 v[142:143], v163 offset:59392
    s_waitcnt lgkmcnt(8)
    v_mfma_f32_16x16x32_bf16 v[16:19], v[144:147], v[116:119], v[16:19]
    v_mfma_f32_16x16x32_bf16 v[20:23], v[148:151], v[116:119], v[20:23]
    v_mfma_f32_16x16x32_bf16 v[24:27], v[152:155], v[116:119], v[24:27]
    v_mfma_f32_16x16x32_bf16 v[28:31], v[156:159], v[116:119], v[28:31]
    ds_read_b64_tr_b16 v[144:145], v160 offset:61440
    ds_read_b64_tr_b16 v[146:147], v160 offset:63488
    ds_read_b64_tr_b16 v[148:149], v161 offset:61440
    ds_read_b64_tr_b16 v[150:151], v161 offset:63488
    ds_read_b64_tr_b16 v[152:153], v162 offset:61440
    ds_read_b64_tr_b16 v[154:155], v162 offset:63488
    ds_read_b64_tr_b16 v[156:157], v163 offset:61440
    ds_read_b64_tr_b16 v[158:159], v163 offset:63488
    s_waitcnt lgkmcnt(8)
    v_mfma_f32_16x16x32_bf16 v[16:19], v[128:131], v[120:123], v[16:19]
    v_mfma_f32_16x16x32_bf16 v[20:23], v[132:135], v[120:123], v[20:23]
    v_mfma_f32_16x16x32_bf16 v[24:27], v[136:139], v[120:123], v[24:27]
    v_mfma_f32_16x16x32_bf16 v[28:31], v[140:143], v[120:123], v[28:31]
    s_waitcnt lgkmcnt(0)
    v_mfma_f32_16x16x32_bf16 v[16:19], v[144:147], v[124:127], v[16:19]
    v_mfma_f32_16x16x32_bf16 v[20:23], v[148:151], v[124:127], v[20:23]
    v_mfma_f32_16x16x32_bf16 v[24:27], v[152:155], v[124:127], v[24:27]
    v_mfma_f32_16x16x32_bf16 v[28:31], v[156:159], v[124:127], v[28:31]
L_gemm_done:
    v_mov_b32 v60, 0
    v_mov_b32 v61, 0x3f803f80
    v_mov_b32 v72, 0
    v_mov_b32 v73, 0
    v_mov_b32 v74, 0
    v_mov_b32 v75, s52
    s_lshl_b32 s59, s56, 11
    s_add_u32 s59, s59, 8519680
    s_lshl_b32 s54, s57, 8
    s_add_u32 s54, s54, s59
    s_waitcnt vmcnt(0)
    v_cvt_pk_bf16_f32 v76, v16, v17
    v_lshlrev_b32 v78, 16, v32
    v_and_b32 v79, 0xffff0000, v32
    v_and_b32 v77, 0xffff0000, v76
    v_lshlrev_b32 v76, 16, v76
    v_add_f32 v76, v76, v78
    v_add_f32 v77, v77, v79
    v_cvt_pk_bf16_f32 v48, v76, v77
    v_cvt_pk_bf16_f32 v76, v18, v19
    v_lshlrev_b32 v78, 16, v33
    v_and_b32 v79, 0xffff0000, v33
    v_and_b32 v77, 0xffff0000, v76
    v_lshlrev_b32 v76, 16, v76
    v_add_f32 v76, v76, v78
    v_add_f32 v77, v77, v79
    v_cvt_pk_bf16_f32 v49, v76, v77
    v_cvt_pk_bf16_f32 v76, v20, v21
    v_lshlrev_b32 v78, 16, v34
    v_and_b32 v79, 0xffff0000, v34
    v_and_b32 v77, 0xffff0000, v76
    v_lshlrev_b32 v76, 16, v76
    v_add_f32 v76, v76, v78
    v_add_f32 v77, v77, v79
    v_cvt_pk_bf16_f32 v50, v76, v77
    v_cvt_pk_bf16_f32 v76, v22, v23
    v_lshlrev_b32 v78, 16, v35
    v_and_b32 v79, 0xffff0000, v35
    v_and_b32 v77, 0xffff0000, v76
    v_lshlrev_b32 v76, 16, v76
    v_add_f32 v76, v76, v78
    v_add_f32 v77, v77, v79
    v_cvt_pk_bf16_f32 v51, v76, v77
    v_cvt_pk_bf16_f32 v76, v24, v25
    v_lshlrev_b32 v78, 16, v36
    v_and_b32 v79, 0xffff0000, v36
    v_and_b32 v77, 0xffff0000, v76
    v_lshlrev_b32 v76, 16, v76
    v_add_f32 v76, v76, v78
    v_add_f32 v77, v77, v79
    v_cvt_pk_bf16_f32 v52, v76, v77
    v_cvt_pk_bf16_f32 v76, v26, v27
    v_lshlrev_b32 v78, 16, v37
    v_and_b32 v79, 0xffff0000, v37
    v_and_b32 v77, 0xffff0000, v76
    v_lshlrev_b32 v76, 16, v76
    v_add_f32 v76, v76, v78
    v_add_f32 v77, v77, v79
    v_cvt_pk_bf16_f32 v53, v76, v77
    v_cvt_pk_bf16_f32 v76, v28, v29
    v_lshlrev_b32 v78, 16, v38
    v_and_b32 v79, 0xffff0000, v38
    v_and_b32 v77, 0xffff0000, v76
    v_lshlrev_b32 v76, 16, v76
    v_add_f32 v76, v76, v78
    v_add_f32 v77, v77, v79
    v_cvt_pk_bf16_f32 v54, v76, v77
    v_cvt_pk_bf16_f32 v76, v30, v31
    v_lshlrev_b32 v78, 16, v39
    v_and_b32 v79, 0xffff0000, v39
    v_and_b32 v77, 0xffff0000, v76
    v_lshlrev_b32 v76, 16, v76
    v_add_f32 v76, v76, v78
    v_add_f32 v77, v77, v79
    v_cvt_pk_bf16_f32 v55, v76, v77
    s_nop 0
    v_dot2_f32_bf16 v72, v48, v61, v72
    v_dot2_f32_bf16 v73, v48, v48, v73
    v_dot2_f32_bf16 v74, v48, v40, v74
    v_dot2_f32_bf16 v72, v49, v61, v72
    v_dot2_f32_bf16 v73, v49, v49, v73
    v_dot2_f32_bf16 v74, v49, v41, v74
    v_dot2_f32_bf16 v72, v50, v61, v72
    v_dot2_f32_bf16 v73, v50, v50, v73
    v_dot2_f32_bf16 v74, v50, v42, v74
    v_dot2_f32_bf16 v72, v51, v61, v72
    v_dot2_f32_bf16 v73, v51, v51, v73
    v_dot2_f32_bf16 v74, v51, v43, v74
    v_dot2_f32_bf16 v72, v52, v61, v72
    v_dot2_f32_bf16 v73, v52, v52, v73
    v_dot2_f32_bf16 v74, v52, v44, v74
    v_dot2_f32_bf16 v72, v53, v61, v72
    v_dot2_f32_bf16 v73, v53, v53, v73
    v_dot2_f32_bf16 v74, v53, v45, v74
    v_dot2_f32_bf16 v72, v54, v61, v72
    v_dot2_f32_bf16 v73, v54, v54, v73
    v_dot2_f32_bf16 v74, v54, v46, v74
    v_dot2_f32_bf16 v72, v55, v61, v72
    v_dot2_f32_bf16 v73, v55, v55, v73
    v_dot2_f32_bf16 v74, v55, v47, v74
    ds_write_b64 v12, v[48:49] offset:0
    ds_write_b64 v12, v[50:51] offset:32
    ds_write_b64 v12, v[52:53] offset:64
    ds_write_b64 v12, v[54:55] offset:96
    v_mov_b32 v76, v72
    v_mov_b32 v77, v73
    v_mov_b32 v78, v74
    s_nop 0
    v_permlane16_swap_b32 v72, v76
    v_permlane16_swap_b32 v73, v77
    v_permlane16_swap_b32 v74, v78
    v_add_f32 v72, v72, v76
    v_add_f32 v73, v73, v77
    v_add_f32 v74, v74, v78
    v_mov_b32 v76, v72
    v_mov_b32 v77, v73
    v_mov_b32 v78, v74
    s_nop 0
    v_permlane32_swap_b32 v72, v76
    v_permlane32_swap_b32 v73, v77
    v_permlane32_swap_b32 v74, v78
    v_add_f32 v72, v72, v76
    v_add_f32 v73, v73, v77
    v_add_f32 v74, v74, v78
    s_mov_b64 exec, 0xffff
    s_cmp_eq_u32 s13, 1
    s_cbranch_scc0 L_rem_60
    buffer_store_dwordx4 v[72:75], v3, s[24:27], s54 offen
    s_branch L_pst_61
L_rem_60:
    buffer_store_dwordx4 v[72:75], v3, s[24:27], s54 offen sc1
L_pst_61:
    s_mov_b64 exec, -1
    buffer_load_dwordx4 v[80:83], v3, s[24:27], s59 offen sc1
    buffer_load_dwordx4 v[76:79], v3, s[24:27], s59 offen offset:1024 sc1
    v_dot2_f32_bf16 v60, v56, v61, v60
    v_dot2_f32_bf16 v60, v57, v61, v60
    v_dot2_f32_bf16 v60, v58, v61, v60
    v_dot2_f32_bf16 v60, v59, v61, v60
    s_nop 2
    s_nop 1
    v_add_f32_dpp v60, v60, v60 row_ror:1 row_mask:0xf bank_mask:0xf
    s_nop 1
    v_add_f32_dpp v60, v60, v60 row_ror:2 row_mask:0xf bank_mask:0xf
    s_nop 1
    v_add_f32_dpp v60, v60, v60 row_ror:4 row_mask:0xf bank_mask:0xf
    s_nop 1
    v_add_f32_dpp v60, v60, v60 row_ror:8 row_mask:0xf bank_mask:0xf
    v_mov_b32 v61, v60
    s_nop 1
    v_permlane16_swap_b32 v60, v61
    v_add_f32 v60, v60, v61
    v_mov_b32 v61, v60
    s_nop 1
    v_permlane32_swap_b32 v60, v61
    v_add_f32 v60, v60, v61
    s_waitcnt lgkmcnt(0)
    ds_read_b128 v[48:51], v13
    ds_read_b128 v[52:55], v13 offset:1152
    s_branch L_pschk
L_ps_62:
    s_cmp_eq_u32 s53, 0
    s_cbranch_scc1 L_pso_63
    s_sub_u32 s53, s53, 1
    buffer_load_dwordx4 v[80:83], v3, s[24:27], s59 offen sc1
    buffer_load_dwordx4 v[76:79], v3, s[24:27], s59 offen offset:1024 sc1
L_pschk:
    s_waitcnt vmcnt(0)
    v_cmp_eq_u32 vcc, s52, v83
    v_cmp_eq_u32 s[54:55], s52, v79
    s_and_b64 vcc, vcc, s[54:55]
    s_cmp_eq_u64 vcc, exec
    s_cbranch_scc0 L_ps_62
L_pso_63:
    v_add_f32 v72, v80, v76
    v_add_f32 v73, v81, v77
    v_add_f32 v74, v82, v78
    v_mov_b32 v76, v72
    v_mov_b32 v77, v73
    v_mov_b32 v78, v74
    s_nop 0
    v_permlane16_swap_b32 v72, v76
    v_permlane16_swap_b32 v73, v77
    v_permlane16_swap_b32 v74, v78
    v_add_f32 v72, v72, v76
    v_add_f32 v73, v73, v77
    v_add_f32 v74, v74, v78
    v_mov_b32 v76, v72
    v_mov_b32 v77, v73
    v_mov_b32 v78, v74
    s_nop 0
    v_permlane32_swap_b32 v72, v76
    v_permlane32_swap_b32 v73, v77
    v_permlane32_swap_b32 v74, v78
    v_add_f32 v72, v72, v76
    v_add_f32 v73, v73, v77
    v_add_f32 v74, v74, v78
    v_mul_f32 v80, 0x3b000000, v72
    v_mul_f32 v76, 0x3b000000, v73
    v_fma_f32 v76, -v80, v80, v76
    v_max_f32 v76, 0, v76
    v_cvt_pk_bf16_f32 v76, v76, v76
    v_and_b32 v76, 0xffff0000, v76
    v_add_f32 v76, 0x3727c5ac, v76
    v_cvt_pk_bf16_f32 v76, v76, v76
    v_and_b32 v76, 0xffff0000, v76
    v_sqrt_f32 v76, v76
    s_nop 0
    v_cvt_pk_bf16_f32 v82, v76, v76
    v_and_b32 v82, 0xffff0000, v82
    v_cvt_pk_bf16_f32 v80, v80, v80
    v_and_b32 v80, 0xffff0000, v80
    v_rcp_f32 v81, v82
    s_nop 0
    s_cmp_lg_u32 s57, 0
    s_cbranch_scc1 L_nor_64
    v_fma_f32 v76, -v80, v60, v74
    v_mul_f32 v76, v76, v81
    v_cvt_pk_bf16_f32 v76, v76, v76
    v_and_b32 v76, 0xffff0000, v76
    v_ashrrev_i32 v77, 31, v76
    v_or_b32 v77, 0x80000000, v77
    v_xor_b32 v76, v76, v77
    v_and_b32 v76, 0xffff0000, v76
    s_lshl_b32 s54, s56, 4
    s_sub_u32 s55, 2047, s54
    v_sub_u32 v77, s55, v4
    v_or_b32 v76, v76, v77
    v_mov_b32 v77, s52
    v_lshlrev_b32 v84, 14, v5
    v_lshl_add_u32 v84, v4, 3, v84
    s_lshl_b32 s54, s56, 7
    s_add_u32 s55, s54, 8912896
    buffer_store_dwordx2 v[76:77], v84, s[24:27], s55 offen sc1
L_nor_64:
    v_mov_b32 v6, 162860
    v_mov_b32 v7, 1
    s_mov_b64 exec, 1
    ds_add_u32 v6, v7
    s_mov_b64 exec, -1
    v_lshlrev_b32 v6, 3, v4
    v_add_u32 v6, s15, v6
    v_lshlrev_b32 v7, 3, v14
    v_add_u32 v7, s15, v7
    ds_write_b64 v6, v[80:81] offset:4096
    s_add_u32 s54, s58, 6291456
    s_add_u32 s55, s3, 6291456
    s_waitcnt lgkmcnt(0)
    ds_read_b64 v[86:87], v7 offset:4096
    ds_read_b64 v[88:89], v7 offset:4160
    buffer_store_dwordx4 v[48:51], v10, s[24:27], s54 offen sc1
    buffer_store_dwordx4 v[52:55], v10, s[24:27], s55 offen sc1
    s_waitcnt lgkmcnt(0)
    v_lshlrev_b32 v92, 16, v48
    v_and_b32 v93, 0xffff0000, v48
    v_sub_f32 v94, v92, v86
    v_sub_f32 v95, v93, v86
    v_cvt_pk_bf16_f32 v96, v94, v95
    v_lshlrev_b32 v94, 16, v96
    v_and_b32 v95, 0xffff0000, v96
    v_mul_f32 v94, v94, v87
    v_mul_f32 v95, v95, v87
    v_cvt_pk_bf16_f32 v100, v94, v95
    v_lshlrev_b32 v94, 16, v100
    v_and_b32 v95, 0xffff0000, v100
    v_add_f32 v94, v94, v92
    v_add_f32 v95, v95, v93
    v_cvt_pk_bf16_f32 v64, v94, v95
    v_lshlrev_b32 v92, 16, v49
    v_and_b32 v93, 0xffff0000, v49
    v_sub_f32 v94, v92, v86
    v_sub_f32 v95, v93, v86
    v_cvt_pk_bf16_f32 v96, v94, v95
    v_lshlrev_b32 v94, 16, v96
    v_and_b32 v95, 0xffff0000, v96
    v_mul_f32 v94, v94, v87
    v_mul_f32 v95, v95, v87
    v_cvt_pk_bf16_f32 v101, v94, v95
    v_lshlrev_b32 v94, 16, v101
    v_and_b32 v95, 0xffff0000, v101
    v_add_f32 v94, v94, v92
    v_add_f32 v95, v95, v93
    v_cvt_pk_bf16_f32 v65, v94, v95
    v_lshlrev_b32 v92, 16, v50
    v_and_b32 v93, 0xffff0000, v50
    v_sub_f32 v94, v92, v86
    v_sub_f32 v95, v93, v86
    v_cvt_pk_bf16_f32 v96, v94, v95
    v_lshlrev_b32 v94, 16, v96
    v_and_b32 v95, 0xffff0000, v96
    v_mul_f32 v94, v94, v87
    v_mul_f32 v95, v95, v87
    v_cvt_pk_bf16_f32 v102, v94, v95
    v_lshlrev_b32 v94, 16, v102
    v_and_b32 v95, 0xffff0000, v102
    v_add_f32 v94, v94, v92
    v_add_f32 v95, v95, v93
    v_cvt_pk_bf16_f32 v66, v94, v95
    v_lshlrev_b32 v92, 16, v51
    v_and_b32 v93, 0xffff0000, v51
    v_sub_f32 v94, v92, v86
    v_sub_f32 v95, v93, v86
    v_cvt_pk_bf16_f32 v96, v94, v95
    v_lshlrev_b32 v94, 16, v96
    v_and_b32 v95, 0xffff0000, v96
    v_mul_f32 v94, v94, v87
    v_mul_f32 v95, v95, v87
    v_cvt_pk_bf16_f32 v103, v94, v95
    v_lshlrev_b32 v94, 16, v103
    v_and_b32 v95, 0xffff0000, v103
    v_add_f32 v94, v94, v92
    v_add_f32 v95, v95, v93
    v_cvt_pk_bf16_f32 v67, v94, v95
    v_lshlrev_b32 v92, 16, v52
    v_and_b32 v93, 0xffff0000, v52
    v_sub_f32 v94, v92, v88
    v_sub_f32 v95, v93, v88
    v_cvt_pk_bf16_f32 v96, v94, v95
    v_lshlrev_b32 v94, 16, v96
    v_and_b32 v95, 0xffff0000, v96
    v_mul_f32 v94, v94, v89
    v_mul_f32 v95, v95, v89
    v_cvt_pk_bf16_f32 v104, v94, v95
    v_lshlrev_b32 v94, 16, v104
    v_and_b32 v95, 0xffff0000, v104
    v_add_f32 v94, v94, v92
    v_add_f32 v95, v95, v93
    v_cvt_pk_bf16_f32 v68, v94, v95
    v_lshlrev_b32 v92, 16, v53
    v_and_b32 v93, 0xffff0000, v53
    v_sub_f32 v94, v92, v88
    v_sub_f32 v95, v93, v88
    v_cvt_pk_bf16_f32 v96, v94, v95
    v_lshlrev_b32 v94, 16, v96
    v_and_b32 v95, 0xffff0000, v96
    v_mul_f32 v94, v94, v89
    v_mul_f32 v95, v95, v89
    v_cvt_pk_bf16_f32 v105, v94, v95
    v_lshlrev_b32 v94, 16, v105
    v_and_b32 v95, 0xffff0000, v105
    v_add_f32 v94, v94, v92
    v_add_f32 v95, v95, v93
    v_cvt_pk_bf16_f32 v69, v94, v95
    v_lshlrev_b32 v92, 16, v54
    v_and_b32 v93, 0xffff0000, v54
    v_sub_f32 v94, v92, v88
    v_sub_f32 v95, v93, v88
    v_cvt_pk_bf16_f32 v96, v94, v95
    v_lshlrev_b32 v94, 16, v96
    v_and_b32 v95, 0xffff0000, v96
    v_mul_f32 v94, v94, v89
    v_mul_f32 v95, v95, v89
    v_cvt_pk_bf16_f32 v106, v94, v95
    v_lshlrev_b32 v94, 16, v106
    v_and_b32 v95, 0xffff0000, v106
    v_add_f32 v94, v94, v92
    v_add_f32 v95, v95, v93
    v_cvt_pk_bf16_f32 v70, v94, v95
    v_lshlrev_b32 v92, 16, v55
    v_and_b32 v93, 0xffff0000, v55
    v_sub_f32 v94, v92, v88
    v_sub_f32 v95, v93, v88
    v_cvt_pk_bf16_f32 v96, v94, v95
    v_lshlrev_b32 v94, 16, v96
    v_and_b32 v95, 0xffff0000, v96
    v_mul_f32 v94, v94, v89
    v_mul_f32 v95, v95, v89
    v_cvt_pk_bf16_f32 v107, v94, v95
    v_lshlrev_b32 v94, 16, v107
    v_and_b32 v95, 0xffff0000, v107
    v_add_f32 v94, v94, v92
    v_add_f32 v95, v95, v93
    v_cvt_pk_bf16_f32 v71, v94, v95
    s_add_u32 s54, s58, 10485760
    s_add_u32 s55, s3, 10485760
    buffer_store_dwordx4 v[100:103], v10, s[24:27], s54 offen sc1
    buffer_store_dwordx4 v[104:107], v10, s[24:27], s55 offen sc1
    buffer_store_dwordx4 v[64:67], v10, s[28:31], s58 offen sc1
    buffer_store_dwordx4 v[68:71], v10, s[28:31], s3 offen sc1
    s_lshl_b32 s54, s56, 7
    s_lshl_b32 s55, s57, 2
    s_add_u32 s54, s54, s55
    s_add_u32 s54, s54, 8486912
    v_mov_b32 v6, 0
    v_mov_b32 v7, s52
    s_waitcnt vmcnt(0)
    s_mov_b64 exec, 1
    buffer_store_dword v7, v6, s[24:27], s54 offen sc1
    s_mov_b64 exec, -1
    s_branch L_end
L_team:
    s_sub_u32 s14, s12, 4
    s_cmp_eq_u32 s101, 0
    s_cbranch_scc1 L_end
    s_cmp_eq_u32 s101, 1
    s_cbranch_scc1 L_role_65
    s_mov_b32 s54, s100
    s_sub_u32 s55, s14, 1
    s_cmp_ge_u32 s55, 2
    s_cbranch_scc1 L_role_65
    v_lshrrev_b32 v6, 1, v1
    v_and_b32 v7, 3, v6
    v_bfe_u32 v8, v6, 4, 1
    v_lshl_or_b32 v7, v8, 2, v7
    v_bfe_u32 v8, v6, 2, 2
    v_lshl_or_b32 v7, v8, 3, v7
    v_and_b32 v8, 1, v1
    v_lshlrev_b32 v8, 4, v8
    v_lshl_add_u32 v6, v7, 10, v8
    s_lshl_b32 s54, s54, 5
    s_lshl_b32 s55, s55, 15
    s_add_u32 s54, s54, s55
    s_add_u32 s54, s54, 1343488
    s_add_u32 s55, s56, 4096
    s_mov_b32 m0, s55
    s_mov_b32 s32, s50
    s_and_b32 s33, s51, 0xffff
    s_mov_b32 s34, 1409024
    s_mov_b32 s35, 0x00020000
    buffer_load_dwordx4 v6, s[32:35], s54 offen lds
L_role_65:
    v_mov_b32 v6, 162860
L_lw_67:
    s_sleep 2
    ds_read_b32 v7, v6
    s_waitcnt lgkmcnt(0)
    v_readfirstlane_b32 s54, v7
    s_cmp_lt_u32 s54, 4
    s_cbranch_scc1 L_lw_67
    s_and_b32 s54, s2, 3
    s_lshl_b32 s54, s54, 14
    s_lshl_b32 s55, s14, 10
    s_add_u32 s54, s54, s55
    s_add_u32 s57, s54, 8912896
    s_add_u32 s58, s57, 4096
    s_add_u32 s59, s57, 8192
    s_add_u32 s60, s57, 12288
    s_mov_b32 s61, 15
L_pr_68:
    s_cmp_eq_u32 s53, 0
    s_cbranch_scc1 L_pro_69
    s_sub_u32 s53, s53, 1
    s_bitcmp1_b32 s61, 0
    s_cbranch_scc0 L_pk_70
    buffer_load_dwordx4 v[16:19], v3, s[24:27], s57 offen sc1
L_pk_70:
    s_bitcmp1_b32 s61, 1
    s_cbranch_scc0 L_pk_71
    buffer_load_dwordx4 v[20:23], v3, s[24:27], s58 offen sc1
L_pk_71:
    s_bitcmp1_b32 s61, 2
    s_cbranch_scc0 L_pk_72
    buffer_load_dwordx4 v[24:27], v3, s[24:27], s59 offen sc1
L_pk_72:
    s_bitcmp1_b32 s61, 3
    s_cbranch_scc0 L_pk_73
    buffer_load_dwordx4 v[28:31], v3, s[24:27], s60 offen sc1
L_pk_73:
    s_waitcnt vmcnt(0)
    s_mov_b32 s61, 0
    v_cmp_ne_u32 vcc, s52, v17
    v_cmp_ne_u32 s[54:55], s52, v19
    s_or_b64 vcc, vcc, s[54:55]
    s_cselect_b32 s54, 1, 0
    s_or_b32 s61, s61, s54
    v_cmp_ne_u32 vcc, s52, v21
    v_cmp_ne_u32 s[54:55], s52, v23
    s_or_b64 vcc, vcc, s[54:55]
    s_cselect_b32 s54, 2, 0
    s_or_b32 s61, s61, s54
    v_cmp_ne_u32 vcc, s52, v25
    v_cmp_ne_u32 s[54:55], s52, v27
    s_or_b64 vcc, vcc, s[54:55]
    s_cselect_b32 s54, 4, 0
    s_or_b32 s61, s61, s54
    v_cmp_ne_u32 vcc, s52, v29
    v_cmp_ne_u32 s[54:55], s52, v31
    s_or_b64 vcc, vcc, s[54:55]
    s_cselect_b32 s54, 8, 0
    s_or_b32 s61, s61, s54
    s_cmp_eq_u32 s61, 0
    s_cbranch_scc1 L_pro_69
    s_sleep 2
    s_branch L_pr_68
L_pro_69:
    v_max3_u32 v32, v16, v18, v20
    v_max3_u32 v32, v22, v24, v32
    v_max3_u32 v32, v26, v28, v32
    v_max_u32 v32, v30, v32
    s_nop 1
    v_max_u32_dpp v32, v32, v32 row_ror:1 row_mask:0xf bank_mask:0xf
    s_nop 1
    v_max_u32_dpp v32, v32, v32 row_ror:2 row_mask:0xf bank_mask:0xf
    s_nop 1
    v_max_u32_dpp v32, v32, v32 row_ror:4 row_mask:0xf bank_mask:0xf
    s_nop 1
    v_max_u32_dpp v32, v32, v32 row_ror:8 row_mask:0xf bank_mask:0xf
    v_mov_b32 v33, v32
    s_lshl_b32 s54, s14, 3
    s_add_u32 s54, s54, 162816
    v_permlane16_swap_b32 v32, v33
    v_lshlrev_b32 v34, 2, v13
    v_max_u32 v32, v32, v33
    v_add_u32 v34, s54, v34
    ds_write_b32 v34, v32
    v_mov_b32 v6, 162852
    v_mov_b32 v7, 1
    s_mov_b64 exec, 1
    ds_add_u32 v6, v7
    s_mov_b64 exec, -1
L_ts_74:
    ds_read_b32 v7, v6
    s_waitcnt lgkmcnt(0)
    v_readfirstlane_b32 s54, v7
    s_cmp_lt_u32 s54, 4
    s_cbranch_scc1 L_ts_74
    v_mov_b32 v34, 162816
    ds_read_b128 v[36:39], v34
    ds_read_b128 v[40:43], v34 offset:16
    v_mov_b32 v35, 1
    s_waitcnt lgkmcnt(0)
    v_min3_u32 v32, v36, v37, v38
    v_min3_u32 v32, v39, v40, v32
    v_min3_u32 v32, v41, v42, v32
    v_min_u32 v32, v43, v32
    v_mov_b32 v35, 0
    v_cmp_ge_u32 s[36:37], v16, v32
    v_cmp_ge_u32 s[38:39], v18, v32
    v_cmp_ge_u32 s[40:41], v20, v32
    v_cmp_ge_u32 s[42:43], v22, v32
    v_cmp_ge_u32 s[44:45], v24, v32
    v_cmp_ge_u32 s[46:47], v26, v32
    v_cmp_ge_u32 s[48:49], v28, v32
    v_cmp_ge_u32 s[50:51], v30, v32
    v_addc_co_u32 v35, vcc, 0, v35, s[36:37]
    v_addc_co_u32 v35, vcc, 0, v35, s[38:39]
    v_addc_co_u32 v35, vcc, 0, v35, s[40:41]
    v_addc_co_u32 v35, vcc, 0, v35, s[42:43]
    v_addc_co_u32 v35, vcc, 0, v35, s[44:45]
    v_addc_co_u32 v35, vcc, 0, v35, s[46:47]
    v_addc_co_u32 v35, vcc, 0, v35, s[48:49]
    v_addc_co_u32 v35, vcc, 0, v35, s[50:51]
    v_cmp_lt_u32 vcc, 0, v35
    s_and_saveexec_b64 s[54:55], vcc
    ds_add_rtn_u32 v36, v34, v35 offset:32
    s_mov_b64 exec, s[54:55]
    s_waitcnt lgkmcnt(0)
    v_min_u32 v36, 64, v36
    v_lshl_add_u32 v36, v36, 2, v34
    s_mov_b64 exec, s[36:37]
    ds_write_b32 v36, v16 offset:64
    v_add_u32 v36, 4, v36
    s_mov_b64 exec, s[38:39]
    ds_write_b32 v36, v18 offset:64
    v_add_u32 v36, 4, v36
    s_mov_b64 exec, s[40:41]
    ds_write_b32 v36, v20 offset:64
    v_add_u32 v36, 4, v36
    s_mov_b64 exec, s[42:43]
    ds_write_b32 v36, v22 offset:64
    v_add_u32 v36, 4, v36
    s_mov_b64 exec, s[44:45]
    ds_write_b32 v36, v24 offset:64
    v_add_u32 v36, 4, v36
    s_mov_b64 exec, s[46:47]
    ds_write_b32 v36, v26 offset:64
    v_add_u32 v36, 4, v36
    s_mov_b64 exec, s[48:49]
    ds_write_b32 v36, v28 offset:64
    v_add_u32 v36, 4, v36
    s_mov_b64 exec, s[50:51]
    ds_write_b32 v36, v30 offset:64
    v_add_u32 v36, 4, v36
    s_mov_b64 exec, -1
    v_mov_b32 v6, 162852
    v_mov_b32 v7, 1
    s_mov_b64 exec, 1
    ds_add_u32 v6, v7
    s_mov_b64 exec, -1
L_ts_75:
    ds_read_b32 v7, v6
    s_waitcnt lgkmcnt(0)
    v_readfirstlane_b32 s54, v7
    s_cmp_lt_u32 s54, 8
    s_cbranch_scc1 L_ts_75
    v_lshl_add_u32 v44, v1, 2, v34
    ds_read_b32 v33, v34 offset:32
    ds_read_b32 v20, v44 offset:64
    ds_read_b128 v[64:67], v34 offset:64
    ds_read_b128 v[68:71], v34 offset:80
    ds_read_b128 v[72:75], v34 offset:96
    ds_read_b128 v[76:79], v34 offset:112
    ds_read_b128 v[80:83], v34 offset:128
    ds_read_b128 v[84:87], v34 offset:144
    ds_read_b128 v[88:91], v34 offset:160
    ds_read_b128 v[92:95], v34 offset:176
    ds_read_b128 v[96:99], v34 offset:192
    ds_read_b128 v[100:103], v34 offset:208
    ds_read_b128 v[104:107], v34 offset:224
    ds_read_b128 v[108:111], v34 offset:240
    ds_read_b128 v[112:115], v34 offset:256
    ds_read_b128 v[116:119], v34 offset:272
    ds_read_b128 v[120:123], v34 offset:288
    ds_read_b128 v[124:127], v34 offset:304
    v_mov_b32 v21, 0
    v_mov_b32 v22, 0
    v_mov_b32 v23, 0
    v_mov_b32 v24, 0
    s_waitcnt lgkmcnt(0)
    v_readfirstlane_b32 s57, v33
    s_cmp_gt_u32 s57, 64
    s_cbranch_scc1 L_ovf_76
    s_cmp_lg_u32 s101, 1
    s_cbranch_scc1 L_nt_78
    v_and_b32 v25, 0x7ff, v20
    v_sub_u32 v25, 2047, v25
    v_lshlrev_b32 v25, 10, v25
    s_lshl_b32 s54, s14, 8
    s_add_u32 s54, s54, 10485760
    v_cmp_gt_u32 vcc, s57, v1
    s_mov_b64 exec, vcc
    buffer_load_dword v26, v25, s[24:27], s54 offen sc1
    buffer_load_dword v27, v25, s[24:27], s54 offen offset:128 sc1
    s_mov_b64 exec, -1
L_nt_78:
    v_cmp_gt_u32 vcc, v64, v20
    v_cmp_gt_u32 s[54:55], v65, v20
    v_cmp_gt_u32 s[58:59], v66, v20
    v_cmp_gt_u32 s[60:61], v67, v20
    v_addc_co_u32 v21, vcc, 0, v21, vcc
    v_addc_co_u32 v22, s[54:55], 0, v22, s[54:55]
    v_addc_co_u32 v23, s[58:59], 0, v23, s[58:59]
    v_addc_co_u32 v24, s[60:61], 0, v24, s[60:61]
    v_cmp_gt_u32 vcc, v68, v20
    v_cmp_gt_u32 s[54:55], v69, v20
    v_cmp_gt_u32 s[58:59], v70, v20
    v_cmp_gt_u32 s[60:61], v71, v20
    v_addc_co_u32 v21, vcc, 0, v21, vcc
    v_addc_co_u32 v22, s[54:55], 0, v22, s[54:55]
    v_addc_co_u32 v23, s[58:59], 0, v23, s[58:59]
    v_addc_co_u32 v24, s[60:61], 0, v24, s[60:61]
    s_cmp_le_u32 s57, 8
    s_cbranch_scc1 L_rk_79
    v_cmp_gt_u32 vcc, v72, v20
    v_cmp_gt_u32 s[54:55], v73, v20
    v_cmp_gt_u32 s[58:59], v74, v20
    v_cmp_gt_u32 s[60:61], v75, v20
    v_addc_co_u32 v21, vcc, 0, v21, vcc
    v_addc_co_u32 v22, s[54:55], 0, v22, s[54:55]
    v_addc_co_u32 v23, s[58:59], 0, v23, s[58:59]
    v_addc_co_u32 v24, s[60:61], 0, v24, s[60:61]
    s_cmp_le_u32 s57, 12
    s_cbranch_scc1 L_rk_79
    v_cmp_gt_u32 vcc, v76, v20
    v_cmp_gt_u32 s[54:55], v77, v20
    v_cmp_gt_u32 s[58:59], v78, v20
    v_cmp_gt_u32 s[60:61], v79, v20
    v_addc_co_u32 v21, vcc, 0, v21, vcc
    v_addc_co_u32 v22, s[54:55], 0, v22, s[54:55]
    v_addc_co_u32 v23, s[58:59], 0, v23, s[58:59]
    v_addc_co_u32 v24, s[60:61], 0, v24, s[60:61]
    s_cmp_le_u32 s57, 16
    s_cbranch_scc1 L_rk_79
    v_cmp_gt_u32 vcc, v80, v20
    v_cmp_gt_u32 s[54:55], v81, v20
    v_cmp_gt_u32 s[58:59], v82, v20
    v_cmp_gt_u32 s[60:61], v83, v20
    v_addc_co_u32 v21, vcc, 0, v21, vcc
    v_addc_co_u32 v22, s[54:55], 0, v22, s[54:55]
    v_addc_co_u32 v23, s[58:59], 0, v23, s[58:59]
    v_addc_co_u32 v24, s[60:61], 0, v24, s[60:61]
    s_cmp_le_u32 s57, 20
    s_cbranch_scc1 L_rk_79
    v_cmp_gt_u32 vcc, v84, v20
    v_cmp_gt_u32 s[54:55], v85, v20
    v_cmp_gt_u32 s[58:59], v86, v20
    v_cmp_gt_u32 s[60:61], v87, v20
    v_addc_co_u32 v21, vcc, 0, v21, vcc
    v_addc_co_u32 v22, s[54:55], 0, v22, s[54:55]
    v_addc_co_u32 v23, s[58:59], 0, v23, s[58:59]
    v_addc_co_u32 v24, s[60:61], 0, v24, s[60:61]
    s_cmp_le_u32 s57, 24
    s_cbranch_scc1 L_rk_79
    v_cmp_gt_u32 vcc, v88, v20
    v_cmp_gt_u32 s[54:55], v89, v20
    v_cmp_gt_u32 s[58:59], v90, v20
    v_cmp_gt_u32 s[60:61], v91, v20
    v_addc_co_u32 v21, vcc, 0, v21, vcc
    v_addc_co_u32 v22, s[54:55], 0, v22, s[54:55]
    v_addc_co_u32 v23, s[58:59], 0, v23, s[58:59]
    v_addc_co_u32 v24, s[60:61], 0, v24, s[60:61]
    s_cmp_le_u32 s57, 28
    s_cbranch_scc1 L_rk_79
    v_cmp_gt_u32 vcc, v92, v20
    v_cmp_gt_u32 s[54:55], v93, v20
    v_cmp_gt_u32 s[58:59], v94, v20
    v_cmp_gt_u32 s[60:61], v95, v20
    v_addc_co_u32 v21, vcc, 0, v21, vcc
    v_addc_co_u32 v22, s[54:55], 0, v22, s[54:55]
    v_addc_co_u32 v23, s[58:59], 0, v23, s[58:59]
    v_addc_co_u32 v24, s[60:61], 0, v24, s[60:61]
    s_cmp_le_u32 s57, 32
    s_cbranch_scc1 L_rk_79
    v_cmp_gt_u32 vcc, v96, v20
    v_cmp_gt_u32 s[54:55], v97, v20
    v_cmp_gt_u32 s[58:59], v98, v20
    v_cmp_gt_u32 s[60:61], v99, v20
    v_addc_co_u32 v21, vcc, 0, v21, vcc
    v_addc_co_u32 v22, s[54:55], 0, v22, s[54:55]
    v_addc_co_u32 v23, s[58:59], 0, v23, s[58:59]
    v_addc_co_u32 v24, s[60:61], 0, v24, s[60:61]
    s_cmp_le_u32 s57, 36
    s_cbranch_scc1 L_rk_79
    v_cmp_gt_u32 vcc, v100, v20
    v_cmp_gt_u32 s[54:55], v101, v20
    v_cmp_gt_u32 s[58:59], v102, v20
    v_cmp_gt_u32 s[60:61], v103, v20
    v_addc_co_u32 v21, vcc, 0, v21, vcc
    v_addc_co_u32 v22, s[54:55], 0, v22, s[54:55]
    v_addc_co_u32 v23, s[58:59], 0, v23, s[58:59]
    v_addc_co_u32 v24, s[60:61], 0, v24, s[60:61]
    s_cmp_le_u32 s57, 40
    s_cbranch_scc1 L_rk_79
    v_cmp_gt_u32 vcc, v104, v20
    v_cmp_gt_u32 s[54:55], v105, v20
    v_cmp_gt_u32 s[58:59], v106, v20
    v_cmp_gt_u32 s[60:61], v107, v20
    v_addc_co_u32 v21, vcc, 0, v21, vcc
    v_addc_co_u32 v22, s[54:55], 0, v22, s[54:55]
    v_addc_co_u32 v23, s[58:59], 0, v23, s[58:59]
    v_addc_co_u32 v24, s[60:61], 0, v24, s[60:61]
    s_cmp_le_u32 s57, 44
    s_cbranch_scc1 L_rk_79
    v_cmp_gt_u32 vcc, v108, v20
    v_cmp_gt_u32 s[54:55], v109, v20
    v_cmp_gt_u32 s[58:59], v110, v20
    v_cmp_gt_u32 s[60:61], v111, v20
    v_addc_co_u32 v21, vcc, 0, v21, vcc
    v_addc_co_u32 v22, s[54:55], 0, v22, s[54:55]
    v_addc_co_u32 v23, s[58:59], 0, v23, s[58:59]
    v_addc_co_u32 v24, s[60:61], 0, v24, s[60:61]
    s_cmp_le_u32 s57, 48
    s_cbranch_scc1 L_rk_79
    v_cmp_gt_u32 vcc, v112, v20
    v_cmp_gt_u32 s[54:55], v113, v20
    v_cmp_gt_u32 s[58:59], v114, v20
    v_cmp_gt_u32 s[60:61], v115, v20
    v_addc_co_u32 v21, vcc, 0, v21, vcc
    v_addc_co_u32 v22, s[54:55], 0, v22, s[54:55]
    v_addc_co_u32 v23, s[58:59], 0, v23, s[58:59]
    v_addc_co_u32 v24, s[60:61], 0, v24, s[60:61]
    s_cmp_le_u32 s57, 52
    s_cbranch_scc1 L_rk_79
    v_cmp_gt_u32 vcc, v116, v20
    v_cmp_gt_u32 s[54:55], v117, v20
    v_cmp_gt_u32 s[58:59], v118, v20
    v_cmp_gt_u32 s[60:61], v119, v20
    v_addc_co_u32 v21, vcc, 0, v21, vcc
    v_addc_co_u32 v22, s[54:55], 0, v22, s[54:55]
    v_addc_co_u32 v23, s[58:59], 0, v23, s[58:59]
    v_addc_co_u32 v24, s[60:61], 0, v24, s[60:61]
    s_cmp_le_u32 s57, 56
    s_cbranch_scc1 L_rk_79
    v_cmp_gt_u32 vcc, v120, v20
    v_cmp_gt_u32 s[54:55], v121, v20
    v_cmp_gt_u32 s[58:59], v122, v20
    v_cmp_gt_u32 s[60:61], v123, v20
    v_addc_co_u32 v21, vcc, 0, v21, vcc
    v_addc_co_u32 v22, s[54:55], 0, v22, s[54:55]
    v_addc_co_u32 v23, s[58:59], 0, v23, s[58:59]
    v_addc_co_u32 v24, s[60:61], 0, v24, s[60:61]
    s_cmp_le_u32 s57, 60
    s_cbranch_scc1 L_rk_79
    v_cmp_gt_u32 vcc, v124, v20
    v_cmp_gt_u32 s[54:55], v125, v20
    v_cmp_gt_u32 s[58:59], v126, v20
    v_cmp_gt_u32 s[60:61], v127, v20
    v_addc_co_u32 v21, vcc, 0, v21, vcc
    v_addc_co_u32 v22, s[54:55], 0, v22, s[54:55]
    v_addc_co_u32 v23, s[58:59], 0, v23, s[58:59]
    v_addc_co_u32 v24, s[60:61], 0, v24, s[60:61]
L_rk_79:
    v_add3_u32 v21, v21, v22, v23
    v_add_u32 v21, v21, v24
    v_cmp_gt_u32 vcc, 8, v21
    v_lshlrev_b32 v17, 2, v21
    v_add_u32 v17, s56, v17
    s_and_saveexec_b64 s[54:55], vcc
    ds_write_b32 v17, v20
    s_mov_b64 exec, s[54:55]
    s_branch L_tdone_77
L_ovf_76:
    s_and_b32 s54, s2, 3
    s_lshl_b32 s54, s54, 14
    s_lshl_b32 s55, s14, 10
    s_add_u32 s54, s54, s55
    s_add_u32 s54, s54, 8912896
    buffer_load_dwordx4 v[64:67], v3, s[24:27], s54 offen sc1
    s_and_b32 s54, s2, 3
    s_lshl_b32 s54, s54, 14
    s_lshl_b32 s55, s14, 10
    s_add_u32 s54, s54, s55
    s_add_u32 s54, s54, 8916992
    buffer_load_dwordx4 v[68:71], v3, s[24:27], s54 offen sc1
    s_and_b32 s54, s2, 3
    s_lshl_b32 s54, s54, 14
    s_lshl_b32 s55, s14, 10
    s_add_u32 s54, s54, s55
    s_add_u32 s54, s54, 8921088
    buffer_load_dwordx4 v[72:75], v3, s[24:27], s54 offen sc1
    s_and_b32 s54, s2, 3
    s_lshl_b32 s54, s54, 14
    s_lshl_b32 s55, s14, 10
    s_add_u32 s54, s54, s55
    s_add_u32 s54, s54, 8925184
    buffer_load_dwordx4 v[76:79], v3, s[24:27], s54 offen sc1
    s_waitcnt vmcnt(0)
    v_max3_u32 v32, v64, v66, v68
    v_max3_u32 v32, v70, v72, v32
    v_max3_u32 v32, v74, v76, v32
    v_max_u32 v32, v78, v32
    ds_max_u32 v34, v32 offset:512
    v_mov_b32 v6, 162852
    v_mov_b32 v7, 1
    s_mov_b64 exec, 1
    ds_add_u32 v6, v7
    s_mov_b64 exec, -1
L_ts_80:
    ds_read_b32 v7, v6
    s_waitcnt lgkmcnt(0)
    v_readfirstlane_b32 s54, v7
    s_cmp_lt_u32 s54, 12
    s_cbranch_scc1 L_ts_80
    ds_read_b32 v33, v34 offset:512
    s_waitcnt lgkmcnt(0)
    v_cmp_eq_u32 vcc, v33, v64
    s_nop 1
    v_cndmask_b32 v64, v64, 0, vcc
    v_cmp_eq_u32 vcc, v33, v66
    s_nop 1
    v_cndmask_b32 v66, v66, 0, vcc
    v_cmp_eq_u32 vcc, v33, v68
    s_nop 1
    v_cndmask_b32 v68, v68, 0, vcc
    v_cmp_eq_u32 vcc, v33, v70
    s_nop 1
    v_cndmask_b32 v70, v70, 0, vcc
    v_cmp_eq_u32 vcc, v33, v72
    s_nop 1
    v_cndmask_b32 v72, v72, 0, vcc
    v_cmp_eq_u32 vcc, v33, v74
    s_nop 1
    v_cndmask_b32 v74, v74, 0, vcc
    v_cmp_eq_u32 vcc, v33, v76
    s_nop 1
    v_cndmask_b32 v76, v76, 0, vcc
    v_cmp_eq_u32 vcc, v33, v78
    s_nop 1
    v_cndmask_b32 v78, v78, 0, vcc
    v_mov_b32 v17, s56
    ds_write_b32 v17, v33 offset:0
    v_max3_u32 v32, v64, v66, v68
    v_max3_u32 v32, v70, v72, v32
    v_max3_u32 v32, v74, v76, v32
    v_max_u32 v32, v78, v32
    ds_max_u32 v34, v32 offset:516
    v_mov_b32 v6, 162852
    v_mov_b32 v7, 1
    s_mov_b64 exec, 1
    ds_add_u32 v6, v7
    s_mov_b64 exec, -1
L_ts_81:
    ds_read_b32 v7, v6
    s_waitcnt lgkmcnt(0)
    v_readfirstlane_b32 s54, v7
    s_cmp_lt_u32 s54, 16
    s_cbranch_scc1 L_ts_81
    ds_read_b32 v33, v34 offset:516
    s_waitcnt lgkmcnt(0)
    v_cmp_eq_u32 vcc, v33, v64
    s_nop 1
    v_cndmask_b32 v64, v64, 0, vcc
    v_cmp_eq_u32 vcc, v33, v66
    s_nop 1
    v_cndmask_b32 v66, v66, 0, vcc
    v_cmp_eq_u32 vcc, v33, v68
    s_nop 1
    v_cndmask_b32 v68, v68, 0, vcc
    v_cmp_eq_u32 vcc, v33, v70
    s_nop 1
    v_cndmask_b32 v70, v70, 0, vcc
    v_cmp_eq_u32 vcc, v33, v72
    s_nop 1
    v_cndmask_b32 v72, v72, 0, vcc
    v_cmp_eq_u32 vcc, v33, v74
    s_nop 1
    v_cndmask_b32 v74, v74, 0, vcc
    v_cmp_eq_u32 vcc, v33, v76
    s_nop 1
    v_cndmask_b32 v76, v76, 0, vcc
    v_cmp_eq_u32 vcc, v33, v78
    s_nop 1
    v_cndmask_b32 v78, v78, 0, vcc
    v_mov_b32 v17, s56
    ds_write_b32 v17, v33 offset:4
    v_max3_u32 v32, v64, v66, v68
    v_max3_u32 v32, v70, v72, v32
    v_max3_u32 v32, v74, v76, v32
    v_max_u32 v32, v78, v32
    ds_max_u32 v34, v32 offset:520
    v_mov_b32 v6, 162852
    v_mov_b32 v7, 1
    s_mov_b64 exec, 1
    ds_add_u32 v6, v7
    s_mov_b64 exec, -1
L_ts_82:
    ds_read_b32 v7, v6
    s_waitcnt lgkmcnt(0)
    v_readfirstlane_b32 s54, v7
    s_cmp_lt_u32 s54, 20
    s_cbranch_scc1 L_ts_82
    ds_read_b32 v33, v34 offset:520
    s_waitcnt lgkmcnt(0)
    v_cmp_eq_u32 vcc, v33, v64
    s_nop 1
    v_cndmask_b32 v64, v64, 0, vcc
    v_cmp_eq_u32 vcc, v33, v66
    s_nop 1
    v_cndmask_b32 v66, v66, 0, vcc
    v_cmp_eq_u32 vcc, v33, v68
    s_nop 1
    v_cndmask_b32 v68, v68, 0, vcc
    v_cmp_eq_u32 vcc, v33, v70
    s_nop 1
    v_cndmask_b32 v70, v70, 0, vcc
    v_cmp_eq_u32 vcc, v33, v72
    s_nop 1
    v_cndmask_b32 v72, v72, 0, vcc
    v_cmp_eq_u32 vcc, v33, v74
    s_nop 1
    v_cndmask_b32 v74, v74, 0, vcc
    v_cmp_eq_u32 vcc, v33, v76
    s_nop 1
    v_cndmask_b32 v76, v76, 0, vcc
    v_cmp_eq_u32 vcc, v33, v78
    s_nop 1
    v_cndmask_b32 v78, v78, 0, vcc
    v_mov_b32 v17, s56
    ds_write_b32 v17, v33 offset:8
    v_max3_u32 v32, v64, v66, v68
    v_max3_u32 v32, v70, v72, v32
    v_max3_u32 v32, v74, v76, v32
    v_max_u32 v32, v78, v32
    ds_max_u32 v34, v32 offset:524
    v_mov_b32 v6, 162852
    v_mov_b32 v7, 1
    s_mov_b64 exec, 1
    ds_add_u32 v6, v7
    s_mov_b64 exec, -1
L_ts_83:
    ds_read_b32 v7, v6
    s_waitcnt lgkmcnt(0)
    v_readfirstlane_b32 s54, v7
    s_cmp_lt_u32 s54, 24
    s_cbranch_scc1 L_ts_83
    ds_read_b32 v33, v34 offset:524
    s_waitcnt lgkmcnt(0)
    v_cmp_eq_u32 vcc, v33, v64
    s_nop 1
    v_cndmask_b32 v64, v64, 0, vcc
    v_cmp_eq_u32 vcc, v33, v66
    s_nop 1
    v_cndmask_b32 v66, v66, 0, vcc
    v_cmp_eq_u32 vcc, v33, v68
    s_nop 1
    v_cndmask_b32 v68, v68, 0, vcc
    v_cmp_eq_u32 vcc, v33, v70
    s_nop 1
    v_cndmask_b32 v70, v70, 0, vcc
    v_cmp_eq_u32 vcc, v33, v72
    s_nop 1
    v_cndmask_b32 v72, v72, 0, vcc
    v_cmp_eq_u32 vcc, v33, v74
    s_nop 1
    v_cndmask_b32 v74, v74, 0, vcc
    v_cmp_eq_u32 vcc, v33, v76
    s_nop 1
    v_cndmask_b32 v76, v76, 0, vcc
    v_cmp_eq_u32 vcc, v33, v78
    s_nop 1
    v_cndmask_b32 v78, v78, 0, vcc
    v_mov_b32 v17, s56
    ds_write_b32 v17, v33 offset:12
    v_max3_u32 v32, v64, v66, v68
    v_max3_u32 v32, v70, v72, v32
    v_max3_u32 v32, v74, v76, v32
    v_max_u32 v32, v78, v32
    ds_max_u32 v34, v32 offset:528
    v_mov_b32 v6, 162852
    v_mov_b32 v7, 1
    s_mov_b64 exec, 1
    ds_add_u32 v6, v7
    s_mov_b64 exec, -1
L_ts_84:
    ds_read_b32 v7, v6
    s_waitcnt lgkmcnt(0)
    v_readfirstlane_b32 s54, v7
    s_cmp_lt_u32 s54, 28
    s_cbranch_scc1 L_ts_84
    ds_read_b32 v33, v34 offset:528
    s_waitcnt lgkmcnt(0)
    v_cmp_eq_u32 vcc, v33, v64
    s_nop 1
    v_cndmask_b32 v64, v64, 0, vcc
    v_cmp_eq_u32 vcc, v33, v66
    s_nop 1
    v_cndmask_b32 v66, v66, 0, vcc
    v_cmp_eq_u32 vcc, v33, v68
    s_nop 1
    v_cndmask_b32 v68, v68, 0, vcc
    v_cmp_eq_u32 vcc, v33, v70
    s_nop 1
    v_cndmask_b32 v70, v70, 0, vcc
    v_cmp_eq_u32 vcc, v33, v72
    s_nop 1
    v_cndmask_b32 v72, v72, 0, vcc
    v_cmp_eq_u32 vcc, v33, v74
    s_nop 1
    v_cndmask_b32 v74, v74, 0, vcc
    v_cmp_eq_u32 vcc, v33, v76
    s_nop 1
    v_cndmask_b32 v76, v76, 0, vcc
    v_cmp_eq_u32 vcc, v33, v78
    s_nop 1
    v_cndmask_b32 v78, v78, 0, vcc
    v_mov_b32 v17, s56
    ds_write_b32 v17, v33 offset:16
    v_max3_u32 v32, v64, v66, v68
    v_max3_u32 v32, v70, v72, v32
    v_max3_u32 v32, v74, v76, v32
    v_max_u32 v32, v78, v32
    ds_max_u32 v34, v32 offset:532
    v_mov_b32 v6, 162852
    v_mov_b32 v7, 1
    s_mov_b64 exec, 1
    ds_add_u32 v6, v7
    s_mov_b64 exec, -1
L_ts_85:
    ds_read_b32 v7, v6
    s_waitcnt lgkmcnt(0)
    v_readfirstlane_b32 s54, v7
    s_cmp_lt_u32 s54, 32
    s_cbranch_scc1 L_ts_85
    ds_read_b32 v33, v34 offset:532
    s_waitcnt lgkmcnt(0)
    v_cmp_eq_u32 vcc, v33, v64
    s_nop 1
    v_cndmask_b32 v64, v64, 0, vcc
    v_cmp_eq_u32 vcc, v33, v66
    s_nop 1
    v_cndmask_b32 v66, v66, 0, vcc
    v_cmp_eq_u32 vcc, v33, v68
    s_nop 1
    v_cndmask_b32 v68, v68, 0, vcc
    v_cmp_eq_u32 vcc, v33, v70
    s_nop 1
    v_cndmask_b32 v70, v70, 0, vcc
    v_cmp_eq_u32 vcc, v33, v72
    s_nop 1
    v_cndmask_b32 v72, v72, 0, vcc
    v_cmp_eq_u32 vcc, v33, v74
    s_nop 1
    v_cndmask_b32 v74, v74, 0, vcc
    v_cmp_eq_u32 vcc, v33, v76
    s_nop 1
    v_cndmask_b32 v76, v76, 0, vcc
    v_cmp_eq_u32 vcc, v33, v78
    s_nop 1
    v_cndmask_b32 v78, v78, 0, vcc
    v_mov_b32 v17, s56
    ds_write_b32 v17, v33 offset:20
    v_max3_u32 v32, v64, v66, v68
    v_max3_u32 v32, v70, v72, v32
    v_max3_u32 v32, v74, v76, v32
    v_max_u32 v32, v78, v32
    ds_max_u32 v34, v32 offset:536
    v_mov_b32 v6, 162852
    v_mov_b32 v7, 1
    s_mov_b64 exec, 1
    ds_add_u32 v6, v7
    s_mov_b64 exec, -1
L_ts_86:
    ds_read_b32 v7, v6
    s_waitcnt lgkmcnt(0)
    v_readfirstlane_b32 s54, v7
    s_cmp_lt_u32 s54, 36
    s_cbranch_scc1 L_ts_86
    ds_read_b32 v33, v34 offset:536
    s_waitcnt lgkmcnt(0)
    v_cmp_eq_u32 vcc, v33, v64
    s_nop 1
    v_cndmask_b32 v64, v64, 0, vcc
    v_cmp_eq_u32 vcc, v33, v66
    s_nop 1
    v_cndmask_b32 v66, v66, 0, vcc
    v_cmp_eq_u32 vcc, v33, v68
    s_nop 1
    v_cndmask_b32 v68, v68, 0, vcc
    v_cmp_eq_u32 vcc, v33, v70
    s_nop 1
    v_cndmask_b32 v70, v70, 0, vcc
    v_cmp_eq_u32 vcc, v33, v72
    s_nop 1
    v_cndmask_b32 v72, v72, 0, vcc
    v_cmp_eq_u32 vcc, v33, v74
    s_nop 1
    v_cndmask_b32 v74, v74, 0, vcc
    v_cmp_eq_u32 vcc, v33, v76
    s_nop 1
    v_cndmask_b32 v76, v76, 0, vcc
    v_cmp_eq_u32 vcc, v33, v78
    s_nop 1
    v_cndmask_b32 v78, v78, 0, vcc
    v_mov_b32 v17, s56
    ds_write_b32 v17, v33 offset:24
    v_max3_u32 v32, v64, v66, v68
    v_max3_u32 v32, v70, v72, v32
    v_max3_u32 v32, v74, v76, v32
    v_max_u32 v32, v78, v32
    ds_max_u32 v34, v32 offset:540
    v_mov_b32 v6, 162852
    v_mov_b32 v7, 1
    s_mov_b64 exec, 1
    ds_add_u32 v6, v7
    s_mov_b64 exec, -1
L_ts_87:
    ds_read_b32 v7, v6
    s_waitcnt lgkmcnt(0)
    v_readfirstlane_b32 s54, v7
    s_cmp_lt_u32 s54, 40
    s_cbranch_scc1 L_ts_87
    ds_read_b32 v33, v34 offset:540
    s_waitcnt lgkmcnt(0)
    v_cmp_eq_u32 vcc, v33, v64
    s_nop 1
    v_cndmask_b32 v64, v64, 0, vcc
    v_cmp_eq_u32 vcc, v33, v66
    s_nop 1
    v_cndmask_b32 v66, v66, 0, vcc
    v_cmp_eq_u32 vcc, v33, v68
    s_nop 1
    v_cndmask_b32 v68, v68, 0, vcc
    v_cmp_eq_u32 vcc, v33, v70
    s_nop 1
    v_cndmask_b32 v70, v70, 0, vcc
    v_cmp_eq_u32 vcc, v33, v72
    s_nop 1
    v_cndmask_b32 v72, v72, 0, vcc
    v_cmp_eq_u32 vcc, v33, v74
    s_nop 1
    v_cndmask_b32 v74, v74, 0, vcc
    v_cmp_eq_u32 vcc, v33, v76
    s_nop 1
    v_cndmask_b32 v76, v76, 0, vcc
    v_cmp_eq_u32 vcc, v33, v78
    s_nop 1
    v_cndmask_b32 v78, v78, 0, vcc
    v_mov_b32 v17, s56
    ds_write_b32 v17, v33 offset:28
    s_mov_b32 s63, 8
    s_branch L_tsel
L_tdone_77:
    s_mov_b32 s63, 0
L_tsel:
    v_and_b32 v16, 7, v1
    v_lshlrev_b32 v17, 2, v16
    v_add_u32 v17, s56, v17
    s_waitcnt lgkmcnt(0)
    ds_read_b32 v20, v17
    s_waitcnt lgkmcnt(0)
    v_and_b32 v21, 0x7ff, v20
    v_sub_u32 v21, 2047, v21
    v_lshlrev_b32 v22, 3, v21
    s_mov_b32 s57, 8978432
    s_cmp_eq_u32 s101, 2
    s_cbranch_scc1 L_down
    v_lshlrev_b32 v24, 10, v21
    v_lshl_add_u32 v24, v5, 4, v24
    s_lshl_b32 s58, s14, 8
    s_add_u32 s58, s58, 10485760
    s_lshl_b32 s54, s14, 12
    s_add_u32 s54, s54, 120832
    v_lshlrev_b32 v25, 3, v1
    v_add_u32 v25, s54, v25
    ds_read_b64_tr_b16 v[96:97], v25 offset:0
    ds_read_b64_tr_b16 v[98:99], v25 offset:512
    ds_read_b64_tr_b16 v[100:101], v25 offset:16384
    ds_read_b64_tr_b16 v[102:103], v25 offset:16896
    ds_read_b64_tr_b16 v[104:105], v25 offset:1024
    ds_read_b64_tr_b16 v[106:107], v25 offset:1536
    ds_read_b64_tr_b16 v[108:109], v25 offset:17408
    ds_read_b64_tr_b16 v[110:111], v25 offset:17920
    ds_read_b64_tr_b16 v[112:113], v25 offset:2048
    ds_read_b64_tr_b16 v[114:115], v25 offset:2560
    ds_read_b64_tr_b16 v[116:117], v25 offset:18432
    ds_read_b64_tr_b16 v[118:119], v25 offset:18944
    ds_read_b64_tr_b16 v[120:121], v25 offset:3072
    ds_read_b64_tr_b16 v[122:123], v25 offset:3584
    ds_read_b64_tr_b16 v[124:125], v25 offset:19456
    ds_read_b64_tr_b16 v[126:127], v25 offset:19968
L_ph_88:
    s_cmp_eq_u32 s53, 0
    s_cbranch_scc1 L_pho_89
    s_sub_u32 s53, s53, 1
    buffer_load_dwordx4 v[64:67], v24, s[24:27], s58 offen offset:0 sc1
    buffer_load_dwordx4 v[68:71], v24, s[24:27], s58 offen offset:64 sc1
    buffer_load_dwordx4 v[72:75], v24, s[24:27], s58 offen offset:128 sc1
    buffer_load_dwordx4 v[76:79], v24, s[24:27], s58 offen offset:192 sc1
    s_waitcnt vmcnt(0)
    v_max3_u32 v6, v64, v68, v72
    v_max_u32 v6, v76, v6
    v_cmp_ne_u32 vcc, -1, v6
    s_cmp_eq_u64 vcc, exec
    s_cbranch_scc0 L_ph_88
L_pho_89:
    s_waitcnt lgkmcnt(0)
    v_mfma_f32_16x16x32_bf16 v[40:43], v[96:99], v[64:67], 0
    v_mfma_f32_16x16x32_bf16 v[44:47], v[100:103], v[64:67], 0
    v_mfma_f32_16x16x32_bf16 v[40:43], v[104:107], v[68:71], v[40:43]
    v_mfma_f32_16x16x32_bf16 v[44:47], v[108:111], v[68:71], v[44:47]
    v_mfma_f32_16x16x32_bf16 v[40:43], v[112:115], v[72:75], v[40:43]
    v_mfma_f32_16x16x32_bf16 v[44:47], v[116:119], v[72:75], v[44:47]
    v_mfma_f32_16x16x32_bf16 v[40:43], v[120:123], v[76:79], v[40:43]
    v_mfma_f32_16x16x32_bf16 v[44:47], v[124:127], v[76:79], v[44:47]
    v_add_u32 v25, s56, v3
    s_nop 7
    ds_write_b128 v25, v[40:43] offset:1024
    ds_write_b128 v25, v[44:47] offset:2048
    v_mov_b32 v6, 162852
    v_mov_b32 v7, 1
    s_add_u32 s55, s63, 3
    s_lshl_b32 s55, s55, 2
    s_mov_b64 exec, 1
    ds_add_u32 v6, v7
    s_mov_b64 exec, -1
L_ts_90:
    ds_read_b32 v7, v6
    s_waitcnt lgkmcnt(0)
    v_readfirstlane_b32 s54, v7
    s_cmp_lt_u32 s54, s55
    s_cbranch_scc1 L_ts_90
    s_cmp_lg_u32 s14, 0
    s_cbranch_scc1 L_end
    v_add_u32 v25, 107008, v3
    ds_read_b128 v[64:67], v25 offset:1024
    ds_read_b128 v[68:71], v25 offset:2048
    v_add_u32 v25, 86272, v3
    ds_read_b128 v[72:75], v25 offset:1024
    ds_read_b128 v[76:79], v25 offset:2048
    v_add_u32 v25, 113920, v3
    ds_read_b128 v[80:83], v25 offset:1024
    ds_read_b128 v[84:87], v25 offset:2048
    s_waitcnt lgkmcnt(0)
    v_add_f32 v40, v40, v64
    v_add_f32 v72, v72, v80
    v_add_f32 v40, v40, v72
    v_add_f32 v41, v41, v65
    v_add_f32 v73, v73, v81
    v_add_f32 v41, v41, v73
    v_add_f32 v42, v42, v66
    v_add_f32 v74, v74, v82
    v_add_f32 v42, v42, v74
    v_add_f32 v43, v43, v67
    v_add_f32 v75, v75, v83
    v_add_f32 v43, v43, v75
    v_add_f32 v44, v44, v68
    v_add_f32 v76, v76, v84
    v_add_f32 v44, v44, v76
    v_add_f32 v45, v45, v69
    v_add_f32 v77, v77, v85
    v_add_f32 v45, v45, v77
    v_add_f32 v46, v46, v70
    v_add_f32 v78, v78, v86
    v_add_f32 v46, v46, v78
    v_add_f32 v47, v47, v71
    v_add_f32 v79, v79, v87
    v_add_f32 v47, v47, v79
    v_cvt_pk_bf16_f32 v40, v40, v40
    v_and_b32 v40, 0xffff0000, v40
    v_cvt_pk_bf16_f32 v44, v44, v44
    v_and_b32 v44, 0xffff0000, v44
    v_cvt_pk_bf16_f32 v41, v41, v41
    v_and_b32 v41, 0xffff0000, v41
    v_cvt_pk_bf16_f32 v45, v45, v45
    v_and_b32 v45, 0xffff0000, v45
    v_cvt_pk_bf16_f32 v42, v42, v42
    v_and_b32 v42, 0xffff0000, v42
    v_cvt_pk_bf16_f32 v46, v46, v46
    v_and_b32 v46, 0xffff0000, v46
    v_cvt_pk_bf16_f32 v43, v43, v43
    v_and_b32 v43, 0xffff0000, v43
    v_cvt_pk_bf16_f32 v47, v47, v47
    v_and_b32 v47, 0xffff0000, v47
    v_mul_f32 v64, 0xbfb8aa3b, v40
    v_mul_f32 v65, 0xbfb8aa3b, v41
    v_mul_f32 v66, 0xbfb8aa3b, v42
    v_mul_f32 v67, 0xbfb8aa3b, v43
    v_exp_f32 v64, v64
    v_exp_f32 v65, v65
    v_exp_f32 v66, v66
    v_exp_f32 v67, v67
    v_add_f32 v64, 1.0, v64
    v_add_f32 v65, 1.0, v65
    v_add_f32 v66, 1.0, v66
    v_add_f32 v67, 1.0, v67
    v_rcp_f32 v64, v64
    v_rcp_f32 v65, v65
    v_rcp_f32 v66, v66
    v_rcp_f32 v67, v67
    v_mul_f32 v64, v64, v40
    v_mul_f32 v65, v65, v41
    v_mul_f32 v66, v66, v42
    v_mul_f32 v67, v67, v43
    v_cvt_pk_bf16_f32 v64, v64, v64
    v_and_b32 v64, 0xffff0000, v64
    v_mul_f32 v40, v64, v44
    v_cvt_pk_bf16_f32 v65, v65, v65
    v_and_b32 v65, 0xffff0000, v65
    v_mul_f32 v41, v65, v45
    v_cvt_pk_bf16_f32 v66, v66, v66
    v_and_b32 v66, 0xffff0000, v66
    v_mul_f32 v42, v66, v46
    v_cvt_pk_bf16_f32 v67, v67, v67
    v_and_b32 v67, 0xffff0000, v67
    v_mul_f32 v43, v67, v47
    v_cvt_pk_bf16_f32 v48, v40, v41
    v_cvt_pk_bf16_f32 v49, v42, v43
    v_mov_b32 v52, v48
    v_mov_b32 v53, v49
    v_mov_b32 v50, v48
    v_mov_b32 v51, v49
    v_lshrrev_b32 v16, 1, v5
    v_lshlrev_b32 v18, 4, v4
    v_permlane16_swap_b32 v52, v50
    v_permlane16_swap_b32 v53, v51
    v_lshl_add_u32 v18, v16, 8, v18
    s_lshl_b32 s54, s100, 9
    s_add_u32 s54, s54, 9043968
    s_mov_b32 s60, 0x0000ffff
    s_mov_b32 s61, 0x0000ffff
    s_mov_b64 exec, s[60:61]
    buffer_store_dwordx4 v[48:51], v18, s[24:27], s54 offen sc1
    s_mov_b64 exec, -1
    s_branch L_end
L_down:
    s_mov_b32 s62, s100
    v_lshlrev_b32 v24, 10, v21
    v_lshl_add_u32 v24, v5, 3, v24
    s_lshl_b32 s3, s62, 5
    s_add_u32 s58, s3, 6291456
    v_lshrrev_b32 v28, 4, v21
    v_lshlrev_b32 v28, 7, v28
    s_lshr_b32 s59, s62, 2
    s_lshl_b32 s59, s59, 2
    s_add_u32 s59, s59, 8486912
    s_lshl_b32 s54, s14, 10
    s_add_u32 s54, s54, 120832
    v_lshlrev_b32 v34, 3, v1
    v_add_u32 v35, s56, v34
    v_add_u32 v34, s54, v34
    ds_read_b64_tr_b16 v[108:109], v34 offset:0
    ds_read_b64_tr_b16 v[110:111], v34 offset:512
    ds_read_b64_tr_b16 v[112:113], v34 offset:4096
    ds_read_b64_tr_b16 v[114:115], v34 offset:4608
    ds_read_b64_tr_b16 v[116:117], v34 offset:8192
    ds_read_b64_tr_b16 v[118:119], v34 offset:8704
    ds_read_b64_tr_b16 v[120:121], v34 offset:12288
    ds_read_b64_tr_b16 v[122:123], v34 offset:12800
    ds_read_b64_tr_b16 v[124:125], v34 offset:16384
    ds_read_b64_tr_b16 v[126:127], v34 offset:16896
    ds_read_b64_tr_b16 v[128:129], v34 offset:20480
    ds_read_b64_tr_b16 v[130:131], v34 offset:20992
    ds_read_b64_tr_b16 v[132:133], v34 offset:24576
    ds_read_b64_tr_b16 v[134:135], v34 offset:25088
    ds_read_b64_tr_b16 v[136:137], v34 offset:28672
    ds_read_b64_tr_b16 v[138:139], v34 offset:29184
    ds_read_b64_tr_b16 v[140:141], v34 offset:32768
    ds_read_b64_tr_b16 v[142:143], v34 offset:33280
    ds_read_b64_tr_b16 v[144:145], v34 offset:36864
    ds_read_b64_tr_b16 v[146:147], v34 offset:37376
    v_mov_b32 v148, 0
    v_mov_b32 v104, 0
    v_mov_b32 v149, 0
    v_mov_b32 v105, 0
    v_mov_b32 v150, 0
    v_mov_b32 v106, 0
    v_mov_b32 v151, 0
    v_mov_b32 v107, 0
    s_mov_b32 s61, 0x3ff
    s_cmp_eq_u32 s14, 3
    s_cbranch_scc1 L_dq_93
    s_mov_b32 s61, 0x7ff
    s_cmp_eq_u32 s14, 0
    s_cbranch_scc1 L_dq_91
    ds_read_b64_tr_b16 v[148:149], v35 offset:4096
    ds_read_b64_tr_b16 v[150:151], v35 offset:4608
    s_branch L_dq_93
L_dq_91:
    ds_read_b64_tr_b16 v[148:149], v34 offset:40960
    ds_read_b64_tr_b16 v[150:151], v34 offset:41472
L_dq_93:
L_pd_94:
    s_cmp_eq_u32 s53, 0
    s_cbranch_scc1 L_pdo_95
    s_sub_u32 s53, s53, 1
    s_add_u32 s57, s58, 4194304
    buffer_load_dwordx2 v[26:27], v24, s[24:27], s58 offen sc1
    buffer_load_dwordx2 v[30:31], v24, s[24:27], s57 offen sc1
    buffer_load_dword v29, v28, s[24:27], s59 offen sc1
    s_waitcnt vmcnt(0)
    v_cmp_ne_u32 vcc, -1, v26
    v_cmp_ne_u32 s[54:55], -1, v30
    s_and_b64 vcc, vcc, s[54:55]
    v_cmp_eq_u32 s[54:55], s52, v29
    s_and_b64 vcc, vcc, s[54:55]
    s_cmp_eq_u64 vcc, exec
    s_cbranch_scc1 L_pdo_95
    s_sleep 2
    s_branch L_pd_94
L_pdo_95:
    v_and_b32 v22, 0xffff0000, v20
    v_ashrrev_i32 v28, 31, v22
    v_not_b32 v28, v28
    v_or_b32 v28, 0x80000000, v28
    v_xor_b32 v22, v22, v28
    v_and_b32 v22, 0xffff0000, v22
    v_mul_f32 v22, 0xbfb8aa3b, v22
    v_exp_f32 v22, v22
    v_lshlrev_b32 v48, 16, v26
    v_add_f32 v22, 1.0, v22
    v_rcp_f32 v22, v22
    v_and_b32 v49, 0xffff0000, v26
    v_lshlrev_b32 v50, 16, v27
    v_and_b32 v51, 0xffff0000, v27
    v_lshlrev_b32 v52, 16, v30
    v_and_b32 v53, 0xffff0000, v30
    v_lshlrev_b32 v54, 16, v31
    v_and_b32 v55, 0xffff0000, v31
    v_cvt_pk_bf16_f32 v22, v22, v22
    v_and_b32 v22, 0xffff0000, v22
    s_lshl_b32 s58, s14, 10
    s_add_u32 s58, s58, 9043968
L_pa_96:
    s_cmp_eq_u32 s53, 0
    s_cbranch_scc1 L_pao_97
    s_sub_u32 s53, s53, 1
    s_bitcmp1_b32 s61, 0
    s_cbranch_scc0 L_pk_98
    s_add_u32 s54, s58, 0
    buffer_load_dwordx4 v[64:67], v3, s[24:27], s54 offen sc1
L_pk_98:
    s_bitcmp1_b32 s61, 1
    s_cbranch_scc0 L_pk_99
    s_add_u32 s54, s58, 4096
    buffer_load_dwordx4 v[68:71], v3, s[24:27], s54 offen sc1
L_pk_99:
    s_bitcmp1_b32 s61, 2
    s_cbranch_scc0 L_pk_100
    s_add_u32 s54, s58, 8192
    buffer_load_dwordx4 v[72:75], v3, s[24:27], s54 offen sc1
L_pk_100:
    s_bitcmp1_b32 s61, 3
    s_cbranch_scc0 L_pk_101
    s_add_u32 s54, s58, 12288
    buffer_load_dwordx4 v[76:79], v3, s[24:27], s54 offen sc1
L_pk_101:
    s_bitcmp1_b32 s61, 4
    s_cbranch_scc0 L_pk_102
    s_add_u32 s54, s58, 16384
    buffer_load_dwordx4 v[80:83], v3, s[24:27], s54 offen sc1
L_pk_102:
    s_bitcmp1_b32 s61, 5
    s_cbranch_scc0 L_pk_103
    s_add_u32 s54, s58, 20480
    buffer_load_dwordx4 v[84:87], v3, s[24:27], s54 offen sc1
L_pk_103:
    s_bitcmp1_b32 s61, 6
    s_cbranch_scc0 L_pk_104
    s_add_u32 s54, s58, 24576
    buffer_load_dwordx4 v[88:91], v3, s[24:27], s54 offen sc1
L_pk_104:
    s_bitcmp1_b32 s61, 7
    s_cbranch_scc0 L_pk_105
    s_add_u32 s54, s58, 28672
    buffer_load_dwordx4 v[92:95], v3, s[24:27], s54 offen sc1
L_pk_105:
    s_bitcmp1_b32 s61, 8
    s_cbranch_scc0 L_pk_106
    s_add_u32 s54, s58, 32768
    buffer_load_dwordx4 v[96:99], v3, s[24:27], s54 offen sc1
L_pk_106:
    s_bitcmp1_b32 s61, 9
    s_cbranch_scc0 L_pk_107
    s_add_u32 s54, s58, 36864
    buffer_load_dwordx4 v[100:103], v3, s[24:27], s54 offen sc1
L_pk_107:
    s_bitcmp1_b32 s61, 10
    s_cbranch_scc0 L_pk_108
    s_add_u32 s54, s58, 40960
    buffer_load_dwordx4 v[104:107], v3, s[24:27], s54 offen sc1
L_pk_108:
    s_waitcnt vmcnt(0)
    s_mov_b32 s61, 0
    v_cmp_eq_u32 vcc, -1, v64
    s_cmp_lg_u64 vcc, 0
    s_cselect_b32 s54, 1, 0
    s_or_b32 s61, s61, s54
    v_cmp_eq_u32 vcc, -1, v68
    s_cmp_lg_u64 vcc, 0
    s_cselect_b32 s54, 2, 0
    s_or_b32 s61, s61, s54
    v_cmp_eq_u32 vcc, -1, v72
    s_cmp_lg_u64 vcc, 0
    s_cselect_b32 s54, 4, 0
    s_or_b32 s61, s61, s54
    v_cmp_eq_u32 vcc, -1, v76
    s_cmp_lg_u64 vcc, 0
    s_cselect_b32 s54, 8, 0
    s_or_b32 s61, s61, s54
    v_cmp_eq_u32 vcc, -1, v80
    s_cmp_lg_u64 vcc, 0
    s_cselect_b32 s54, 16, 0
    s_or_b32 s61, s61, s54
    v_cmp_eq_u32 vcc, -1, v84
    s_cmp_lg_u64 vcc, 0
    s_cselect_b32 s54, 32, 0
    s_or_b32 s61, s61, s54
    v_cmp_eq_u32 vcc, -1, v88
    s_cmp_lg_u64 vcc, 0
    s_cselect_b32 s54, 64, 0
    s_or_b32 s61, s61, s54
    v_cmp_eq_u32 vcc, -1, v92
    s_cmp_lg_u64 vcc, 0
    s_cselect_b32 s54, 128, 0
    s_or_b32 s61, s61, s54
    v_cmp_eq_u32 vcc, -1, v96
    s_cmp_lg_u64 vcc, 0
    s_cselect_b32 s54, 256, 0
    s_or_b32 s61, s61, s54
    v_cmp_eq_u32 vcc, -1, v100
    s_cmp_lg_u64 vcc, 0
    s_cselect_b32 s54, 512, 0
    s_or_b32 s61, s61, s54
    v_cmp_eq_u32 vcc, -1, v104
    s_cmp_lg_u64 vcc, 0
    s_cselect_b32 s54, 1024, 0
    s_or_b32 s61, s61, s54
    s_cmp_eq_u32 s61, 0
    s_cbranch_scc1 L_pao_97
    s_sleep 2
    s_branch L_pa_96
L_pao_97:
    s_waitcnt lgkmcnt(0)
    v_mfma_f32_16x16x32_bf16 v[40:43], v[108:111], v[64:67], 0
    v_mfma_f32_16x16x32_bf16 v[44:47], v[112:115], v[68:71], 0
    v_mfma_f32_16x16x32_bf16 v[40:43], v[116:119], v[72:75], v[40:43]
    v_mfma_f32_16x16x32_bf16 v[44:47], v[120:123], v[76:79], v[44:47]
    v_mfma_f32_16x16x32_bf16 v[40:43], v[124:127], v[80:83], v[40:43]
    v_mfma_f32_16x16x32_bf16 v[44:47], v[128:131], v[84:87], v[44:47]
    v_mfma_f32_16x16x32_bf16 v[40:43], v[132:135], v[88:91], v[40:43]
    v_mfma_f32_16x16x32_bf16 v[44:47], v[136:139], v[92:95], v[44:47]
    v_mfma_f32_16x16x32_bf16 v[40:43], v[140:143], v[96:99], v[40:43]
    v_mfma_f32_16x16x32_bf16 v[44:47], v[144:147], v[100:103], v[44:47]
    v_mfma_f32_16x16x32_bf16 v[40:43], v[148:151], v[104:107], v[40:43]
    v_add_u32 v25, s56, v3
    s_nop 7
    v_add_f32 v40, v40, v44
    v_add_f32 v41, v41, v45
    v_add_f32 v42, v42, v46
    v_add_f32 v43, v43, v47
    ds_write_b128 v25, v[40:43] offset:1024
    v_mov_b32 v6, 162852
    v_mov_b32 v7, 1
    s_add_u32 s55, s63, 3
    s_lshl_b32 s55, s55, 2
    s_mov_b64 exec, 1
    ds_add_u32 v6, v7
    s_mov_b64 exec, -1
L_ts_109:
    ds_read_b32 v7, v6
    s_waitcnt lgkmcnt(0)
    v_readfirstlane_b32 s54, v7
    s_cmp_lt_u32 s54, s55
    s_cbranch_scc1 L_ts_109
    s_cmp_lg_u32 s14, 0
    s_cbranch_scc1 L_end
    v_add_u32 v25, 107008, v3
    ds_read_b128 v[64:67], v25 offset:1024
    v_add_u32 v25, 86272, v3
    ds_read_b128 v[68:71], v25 offset:1024
    v_add_u32 v25, 113920, v3
    ds_read_b128 v[72:75], v25 offset:1024
    s_waitcnt lgkmcnt(0)
    v_add_f32 v40, v40, v64
    v_add_f32 v68, v68, v72
    v_add_f32 v40, v40, v68
    v_add_f32 v41, v41, v65
    v_add_f32 v69, v69, v73
    v_add_f32 v41, v41, v69
    v_add_f32 v42, v42, v66
    v_add_f32 v70, v70, v74
    v_add_f32 v42, v42, v70
    v_add_f32 v43, v43, v67
    v_add_f32 v71, v71, v75
    v_add_f32 v43, v43, v71
    v_cvt_pk_bf16_f32 v46, v40, v41
    v_cvt_pk_bf16_f32 v47, v42, v43
    v_lshlrev_b32 v40, 16, v46
    v_and_b32 v41, 0xffff0000, v46
    v_lshlrev_b32 v42, 16, v47
    v_and_b32 v43, 0xffff0000, v47
    v_mul_f32 v40, v40, v22
    v_mul_f32 v41, v41, v22
    v_mul_f32 v42, v42, v22
    v_mul_f32 v43, v43, v22
    v_cvt_pk_bf16_f32 v46, v40, v41
    v_cvt_pk_bf16_f32 v47, v42, v43
    v_lshlrev_b32 v40, 16, v46
    v_and_b32 v41, 0xffff0000, v46
    v_lshlrev_b32 v42, 16, v47
    v_and_b32 v43, 0xffff0000, v47
    v_add_f32 v40, v40, v52
    v_add_f32 v41, v41, v53
    v_add_f32 v42, v42, v54
    v_add_f32 v43, v43, v55
    v_cvt_pk_bf16_f32 v46, v40, v41
    v_cvt_pk_bf16_f32 v47, v42, v43
    v_lshlrev_b32 v40, 16, v46
    v_and_b32 v41, 0xffff0000, v46
    v_lshlrev_b32 v42, 16, v47
    v_and_b32 v43, 0xffff0000, v47
    v_add_f32 v40, v40, v48
    v_add_f32 v41, v41, v49
    v_add_f32 v42, v42, v50
    v_add_f32 v43, v43, v51
    v_cvt_pk_bf16_f32 v46, v40, v41
    v_cvt_pk_bf16_f32 v47, v42, v43
    v_cmp_gt_u32 vcc, 8, v4
    s_and_saveexec_b64 s[54:55], vcc
    buffer_store_dwordx2 v[46:47], v24, s[28:31], s3 offen sc1
    s_mov_b64 exec, s[54:55]
    s_cmp_lg_u32 s100, 0
    s_cbranch_scc1 L_end
    v_mov_b32 v6, 0
    v_mov_b32 v7, s52
    s_mov_b32 s54, 8388608
    s_mov_b64 exec, 1
    buffer_store_dword v7, v6, s[24:27], s54 offen sc1
    s_mov_b64 exec, -1
L_end:
L_done:
    s_endpgm
L_loader:
    s_setprio 3
    s_sub_u32 s14, s12, 8
    v_lshrrev_b32 v6, 3, v1
    v_and_b32 v7, 7, v1
    v_lshrrev_b32 v8, 1, v6
    v_xor_b32 v9, v7, v8
    v_lshlrev_b32 v10, 10, v6
    v_lshl_add_u32 v10, v9, 4, v10
    v_xor_b32 v9, 4, v9
    v_lshlrev_b32 v11, 10, v6
    v_lshl_add_u32 v11, v9, 4, v11
    v_add_u32 v11, 0x2000, v11
    s_mul_i32 s54, s14, 48
    s_add_u32 s54, s54, 0
    v_lshrrev_b32 v6, 2, v1
    v_add_u32 v6, s54, v6
    v_lshrrev_b32 v7, 6, v6
    v_and_b32 v6, 63, v6
    v_and_b32 v8, 0x23, v6
    v_bfe_u32 v9, v6, 4, 1
    v_lshl_or_b32 v8, v9, 2, v8
    v_bfe_u32 v9, v6, 2, 2
    v_lshl_or_b32 v8, v9, 3, v8
    v_mul_u32_u24 v8, 3072, v8
    v_lshl_add_u32 v8, v7, 10, v8
    v_bfe_u32 v9, v1, 1, 1
    v_bfe_u32 v7, v6, 2, 1
    v_xor_b32 v9, v9, v7
    v_lshl_add_u32 v8, v9, 5, v8
    v_and_b32 v9, 1, v1
    v_lshl_add_u32 v12, v9, 4, v8
    s_mul_i32 s54, s14, 48
    s_add_u32 s54, s54, 16
    v_lshrrev_b32 v6, 2, v1
    v_add_u32 v6, s54, v6
    v_lshrrev_b32 v7, 6, v6
    v_and_b32 v6, 63, v6
    v_and_b32 v8, 0x23, v6
    v_bfe_u32 v9, v6, 4, 1
    v_lshl_or_b32 v8, v9, 2, v8
    v_bfe_u32 v9, v6, 2, 2
    v_lshl_or_b32 v8, v9, 3, v8
    v_mul_u32_u24 v8, 3072, v8
    v_lshl_add_u32 v8, v7, 10, v8
    v_bfe_u32 v9, v1, 1, 1
    v_bfe_u32 v7, v6, 2, 1
    v_xor_b32 v9, v9, v7
    v_lshl_add_u32 v8, v9, 5, v8
    v_and_b32 v9, 1, v1
    v_lshl_add_u32 v13, v9, 4, v8
    s_mul_i32 s54, s14, 48
    s_add_u32 s54, s54, 32
    v_lshrrev_b32 v6, 2, v1
    v_add_u32 v6, s54, v6
    v_lshrrev_b32 v7, 6, v6
    v_and_b32 v6, 63, v6
    v_and_b32 v8, 0x23, v6
    v_bfe_u32 v9, v6, 4, 1
    v_lshl_or_b32 v8, v9, 2, v8
    v_bfe_u32 v9, v6, 2, 2
    v_lshl_or_b32 v8, v9, 3, v8
    v_mul_u32_u24 v8, 3072, v8
    v_lshl_add_u32 v8, v7, 10, v8
    v_bfe_u32 v9, v1, 1, 1
    v_bfe_u32 v7, v6, 2, 1
    v_xor_b32 v9, v9, v7
    v_lshl_add_u32 v8, v9, 5, v8
    v_and_b32 v9, 1, v1
    v_lshl_add_u32 v14, v9, 4, v8
    s_lshl_b32 s56, s11, 7
    s_lshl_b32 s54, s14, 5
    s_add_u32 s56, s56, s54
    s_lshl_b32 s56, s56, 10
    s_lshl_b32 s57, s10, 6
    s_lshl_b32 s58, s14, 12
    s_mul_i32 s59, s14, 3072
    s_mul_i32 s63, s10, 4
    s_mul_i32 s54, s11, 1
    s_add_u32 s63, s63, s54
    s_waitcnt lgkmcnt(0)
    s_mov_b32 s16, s36
    s_and_b32 s17, s37, 0xffff
    s_mov_b32 s18, 2097152
    s_mov_b32 s19, 0x00020000
    s_mov_b32 s20, s38
    s_and_b32 s21, s39, 0xffff
    s_mov_b32 s22, 1572864
    s_mov_b32 s23, 0x00020000
    s_mov_b32 s24, s8
    s_and_b32 s25, s9, 0xffff
    s_mov_b32 s26, 16777216
    s_mov_b32 s27, 0x00020000
    s_add_u32 s54, s8, 8388608
    s_addc_u32 s55, s9, 0
    s_load_dword s52, s[54:55], 0
    s_add_u32 s62, s63, 0
    s_and_b32 s62, s62, 7
    s_lshl_b32 s55, s62, 7
    s_add_u32 s55, s56, s55
    s_add_u32 s60, s55, 16384
    s_mul_i32 s61, s62, 196608
    s_add_u32 s61, s57, s61
    s_add_u32 s54, s58, 0
    s_mov_b32 m0, s54
    s_nop 0
    buffer_load_dwordx4 v10, s[16:19], s55 offen lds
    s_add_u32 s54, s58, 1024
    s_mov_b32 m0, s54
    s_nop 0
    buffer_load_dwordx4 v11, s[16:19], s55 offen lds
    s_add_u32 s54, s58, 2048
    s_mov_b32 m0, s54
    s_nop 0
    buffer_load_dwordx4 v10, s[16:19], s60 offen lds
    s_add_u32 s54, s58, 3072
    s_mov_b32 m0, s54
    s_nop 0
    buffer_load_dwordx4 v11, s[16:19], s60 offen lds
    s_add_u32 s54, s59, 16384
    s_mov_b32 m0, s54
    s_nop 0
    buffer_load_dwordx4 v12, s[20:23], s61 offen lds
    s_add_u32 s54, s59, 17408
    s_mov_b32 m0, s54
    s_nop 0
    buffer_load_dwordx4 v13, s[20:23], s61 offen lds
    s_add_u32 s54, s59, 18432
    s_mov_b32 m0, s54
    s_nop 0
    buffer_load_dwordx4 v14, s[20:23], s61 offen lds
    s_setprio 0
    s_add_u32 s62, s63, 1
    s_and_b32 s62, s62, 7
    s_lshl_b32 s55, s62, 7
    s_add_u32 s55, s56, s55
    s_add_u32 s60, s55, 16384
    s_mul_i32 s61, s62, 196608
    s_add_u32 s61, s57, s61
    s_add_u32 s54, s58, 28672
    s_mov_b32 m0, s54
    s_nop 0
    buffer_load_dwordx4 v10, s[16:19], s55 offen lds
    s_add_u32 s54, s58, 29696
    s_mov_b32 m0, s54
    s_nop 0
    buffer_load_dwordx4 v11, s[16:19], s55 offen lds
    s_add_u32 s54, s58, 30720
    s_mov_b32 m0, s54
    s_nop 0
    buffer_load_dwordx4 v10, s[16:19], s60 offen lds
    s_add_u32 s54, s58, 31744
    s_mov_b32 m0, s54
    s_nop 0
    buffer_load_dwordx4 v11, s[16:19], s60 offen lds
    s_add_u32 s54, s59, 45056
    s_mov_b32 m0, s54
    s_nop 0
    buffer_load_dwordx4 v12, s[20:23], s61 offen lds
    s_add_u32 s54, s59, 46080
    s_mov_b32 m0, s54
    s_nop 0
    buffer_load_dwordx4 v13, s[20:23], s61 offen lds
    s_add_u32 s54, s59, 47104
    s_mov_b32 m0, s54
    s_nop 0
    buffer_load_dwordx4 v14, s[20:23], s61 offen lds
    v_mov_b32 v16, -1
    v_mov_b32 v17, -1
    v_mov_b32 v18, -1
    v_mov_b32 v19, -1
    v_mov_b32 v20, 0
    v_mov_b32 v21, 0
    v_mov_b32 v22, 0
    v_mov_b32 v23, 0
    v_add_u32 v6, 162816, v3
    ds_write_b128 v6, v[20:23]
    s_waitcnt lgkmcnt(0)
    s_barrier
    s_waitcnt vmcnt(7)
    v_mov_b32 v6, 163392
    v_mov_b32 v7, 1
    s_mov_b64 exec, 1
    ds_add_u32 v6, v7
    s_mov_b64 exec, -1
    s_add_u32 s62, s63, 2
    s_and_b32 s62, s62, 7
    s_lshl_b32 s55, s62, 7
    s_add_u32 s55, s56, s55
    s_add_u32 s60, s55, 16384
    s_mul_i32 s61, s62, 196608
    s_add_u32 s61, s57, s61
    s_add_u32 s54, s58, 57344
    s_mov_b32 m0, s54
    s_nop 0
    buffer_load_dwordx4 v10, s[16:19], s55 offen lds
    s_add_u32 s54, s58, 58368
    s_mov_b32 m0, s54
    s_nop 0
    buffer_load_dwordx4 v11, s[16:19], s55 offen lds
    s_add_u32 s54, s58, 59392
    s_mov_b32 m0, s54
    s_nop 0
    buffer_load_dwordx4 v10, s[16:19], s60 offen lds
    s_add_u32 s54, s58, 60416
    s_mov_b32 m0, s54
    s_nop 0
    buffer_load_dwordx4 v11, s[16:19], s60 offen lds
    s_add_u32 s54, s59, 73728
    s_mov_b32 m0, s54
    s_nop 0
    buffer_load_dwordx4 v12, s[20:23], s61 offen lds
    s_add_u32 s54, s59, 74752
    s_mov_b32 m0, s54
    s_nop 0
    buffer_load_dwordx4 v13, s[20:23], s61 offen lds
    s_add_u32 s54, s59, 75776
    s_mov_b32 m0, s54
    s_nop 0
    buffer_load_dwordx4 v14, s[20:23], s61 offen lds
    s_waitcnt vmcnt(7)
    v_mov_b32 v6, 163396
    v_mov_b32 v7, 1
    s_mov_b64 exec, 1
    ds_add_u32 v6, v7
    s_mov_b64 exec, -1
    s_add_u32 s62, s63, 3
    s_and_b32 s62, s62, 7
    s_lshl_b32 s55, s62, 7
    s_add_u32 s55, s56, s55
    s_add_u32 s60, s55, 16384
    s_mul_i32 s61, s62, 196608
    s_add_u32 s61, s57, s61
    s_add_u32 s54, s58, 86016
    s_mov_b32 m0, s54
    s_nop 0
    buffer_load_dwordx4 v10, s[16:19], s55 offen lds
    s_add_u32 s54, s58, 87040
    s_mov_b32 m0, s54
    s_nop 0
    buffer_load_dwordx4 v11, s[16:19], s55 offen lds
    s_add_u32 s54, s58, 88064
    s_mov_b32 m0, s54
    s_nop 0
    buffer_load_dwordx4 v10, s[16:19], s60 offen lds
    s_add_u32 s54, s58, 89088
    s_mov_b32 m0, s54
    s_nop 0
    buffer_load_dwordx4 v11, s[16:19], s60 offen lds
    s_add_u32 s54, s59, 102400
    s_mov_b32 m0, s54
    s_nop 0
    buffer_load_dwordx4 v12, s[20:23], s61 offen lds
    s_add_u32 s54, s59, 103424
    s_mov_b32 m0, s54
    s_nop 0
    buffer_load_dwordx4 v13, s[20:23], s61 offen lds
    s_add_u32 s54, s59, 104448
    s_mov_b32 m0, s54
    s_nop 0
    buffer_load_dwordx4 v14, s[20:23], s61 offen lds
    s_waitcnt vmcnt(7)
    v_mov_b32 v6, 163400
    v_mov_b32 v7, 1
    s_mov_b64 exec, 1
    ds_add_u32 v6, v7
    s_mov_b64 exec, -1
    s_add_u32 s62, s63, 4
    s_and_b32 s62, s62, 7
    s_lshl_b32 s55, s62, 7
    s_add_u32 s55, s56, s55
    s_add_u32 s60, s55, 16384
    s_mul_i32 s61, s62, 196608
    s_add_u32 s61, s57, s61
    s_add_u32 s54, s58, 114688
    s_mov_b32 m0, s54
    s_nop 0
    buffer_load_dwordx4 v10, s[16:19], s55 offen lds
    s_add_u32 s54, s58, 115712
    s_mov_b32 m0, s54
    s_nop 0
    buffer_load_dwordx4 v11, s[16:19], s55 offen lds
    s_add_u32 s54, s58, 116736
    s_mov_b32 m0, s54
    s_nop 0
    buffer_load_dwordx4 v10, s[16:19], s60 offen lds
    s_add_u32 s54, s58, 117760
    s_mov_b32 m0, s54
    s_nop 0
    buffer_load_dwordx4 v11, s[16:19], s60 offen lds
    s_add_u32 s54, s59, 131072
    s_mov_b32 m0, s54
    s_nop 0
    buffer_load_dwordx4 v12, s[20:23], s61 offen lds
    s_add_u32 s54, s59, 132096
    s_mov_b32 m0, s54
    s_nop 0
    buffer_load_dwordx4 v13, s[20:23], s61 offen lds
    s_add_u32 s54, s59, 133120
    s_mov_b32 m0, s54
    s_nop 0
    buffer_load_dwordx4 v14, s[20:23], s61 offen lds
    s_waitcnt vmcnt(7)
    v_mov_b32 v6, 163404
    v_mov_b32 v7, 1
    s_mov_b64 exec, 1
    ds_add_u32 v6, v7
    s_mov_b64 exec, -1
    v_mov_b32 v6, 163460
L_lw_110:
    s_sleep 0
    ds_read_b32 v7, v6
    s_waitcnt lgkmcnt(0)
    v_readfirstlane_b32 s54, v7
    s_cmp_lt_u32 s54, 8
    s_cbranch_scc1 L_lw_110
    s_add_u32 s62, s63, 5
    s_and_b32 s62, s62, 7
    s_lshl_b32 s55, s62, 7
    s_add_u32 s55, s56, s55
    s_add_u32 s60, s55, 16384
    s_mul_i32 s61, s62, 196608
    s_add_u32 s61, s57, s61
    s_add_u32 s54, s58, 0
    s_mov_b32 m0, s54
    s_nop 0
    buffer_load_dwordx4 v10, s[16:19], s55 offen lds
    s_add_u32 s54, s58, 1024
    s_mov_b32 m0, s54
    s_nop 0
    buffer_load_dwordx4 v11, s[16:19], s55 offen lds
    s_add_u32 s54, s58, 2048
    s_mov_b32 m0, s54
    s_nop 0
    buffer_load_dwordx4 v10, s[16:19], s60 offen lds
    s_add_u32 s54, s58, 3072
    s_mov_b32 m0, s54
    s_nop 0
    buffer_load_dwordx4 v11, s[16:19], s60 offen lds
    s_add_u32 s54, s59, 16384
    s_mov_b32 m0, s54
    s_nop 0
    buffer_load_dwordx4 v12, s[20:23], s61 offen lds
    s_add_u32 s54, s59, 17408
    s_mov_b32 m0, s54
    s_nop 0
    buffer_load_dwordx4 v13, s[20:23], s61 offen lds
    s_add_u32 s54, s59, 18432
    s_mov_b32 m0, s54
    s_nop 0
    buffer_load_dwordx4 v14, s[20:23], s61 offen lds
    s_waitcnt vmcnt(7)
    v_mov_b32 v6, 163408
    v_mov_b32 v7, 1
    s_mov_b64 exec, 1
    ds_add_u32 v6, v7
    s_mov_b64 exec, -1
    v_mov_b32 v6, 163464
L_lw_111:
    s_sleep 0
    ds_read_b32 v7, v6
    s_waitcnt lgkmcnt(0)
    v_readfirstlane_b32 s54, v7
    s_cmp_lt_u32 s54, 8
    s_cbranch_scc1 L_lw_111
    s_add_u32 s62, s63, 6
    s_and_b32 s62, s62, 7
    s_lshl_b32 s55, s62, 7
    s_add_u32 s55, s56, s55
    s_add_u32 s60, s55, 16384
    s_mul_i32 s61, s62, 196608
    s_add_u32 s61, s57, s61
    s_add_u32 s54, s58, 28672
    s_mov_b32 m0, s54
    s_nop 0
    buffer_load_dwordx4 v10, s[16:19], s55 offen lds
    s_add_u32 s54, s58, 29696
    s_mov_b32 m0, s54
    s_nop 0
    buffer_load_dwordx4 v11, s[16:19], s55 offen lds
    s_add_u32 s54, s58, 30720
    s_mov_b32 m0, s54
    s_nop 0
    buffer_load_dwordx4 v10, s[16:19], s60 offen lds
    s_add_u32 s54, s58, 31744
    s_mov_b32 m0, s54
    s_nop 0
    buffer_load_dwordx4 v11, s[16:19], s60 offen lds
    s_add_u32 s54, s59, 45056
    s_mov_b32 m0, s54
    s_nop 0
    buffer_load_dwordx4 v12, s[20:23], s61 offen lds
    s_add_u32 s54, s59, 46080
    s_mov_b32 m0, s54
    s_nop 0
    buffer_load_dwordx4 v13, s[20:23], s61 offen lds
    s_add_u32 s54, s59, 47104
    s_mov_b32 m0, s54
    s_nop 0
    buffer_load_dwordx4 v14, s[20:23], s61 offen lds
    s_waitcnt vmcnt(7)
    v_mov_b32 v6, 163412
    v_mov_b32 v7, 1
    s_mov_b64 exec, 1
    ds_add_u32 v6, v7
    s_mov_b64 exec, -1
    v_mov_b32 v6, 163468
L_lw_112:
    s_sleep 0
    ds_read_b32 v7, v6
    s_waitcnt lgkmcnt(0)
    v_readfirstlane_b32 s54, v7
    s_cmp_lt_u32 s54, 8
    s_cbranch_scc1 L_lw_112
    s_add_u32 s62, s63, 7
    s_and_b32 s62, s62, 7
    s_lshl_b32 s55, s62, 7
    s_add_u32 s55, s56, s55
    s_add_u32 s60, s55, 16384
    s_mul_i32 s61, s62, 196608
    s_add_u32 s61, s57, s61
    s_add_u32 s54, s58, 57344
    s_mov_b32 m0, s54
    s_nop 0
    buffer_load_dwordx4 v10, s[16:19], s55 offen lds
    s_add_u32 s54, s58, 58368
    s_mov_b32 m0, s54
    s_nop 0
    buffer_load_dwordx4 v11, s[16:19], s55 offen lds
    s_add_u32 s54, s58, 59392
    s_mov_b32 m0, s54
    s_nop 0
    buffer_load_dwordx4 v10, s[16:19], s60 offen lds
    s_add_u32 s54, s58, 60416
    s_mov_b32 m0, s54
    s_nop 0
    buffer_load_dwordx4 v11, s[16:19], s60 offen lds
    s_add_u32 s54, s59, 73728
    s_mov_b32 m0, s54
    s_nop 0
    buffer_load_dwordx4 v12, s[20:23], s61 offen lds
    s_add_u32 s54, s59, 74752
    s_mov_b32 m0, s54
    s_nop 0
    buffer_load_dwordx4 v13, s[20:23], s61 offen lds
    s_add_u32 s54, s59, 75776
    s_mov_b32 m0, s54
    s_nop 0
    buffer_load_dwordx4 v14, s[20:23], s61 offen lds
    s_waitcnt vmcnt(7)
    v_mov_b32 v6, 163416
    v_mov_b32 v7, 1
    s_mov_b64 exec, 1
    ds_add_u32 v6, v7
    s_mov_b64 exec, -1
    s_waitcnt vmcnt(0)
    v_mov_b32 v6, 163420
    v_mov_b32 v7, 1
    s_mov_b64 exec, 1
    ds_add_u32 v6, v7
    s_mov_b64 exec, -1
    s_waitcnt lgkmcnt(0)
    s_barrier
    s_barrier
    s_add_u32 s52, s52, 1
    s_and_b32 s54, s2, 7
    s_bfe_u32 s55, s2, 0x40003
    s_mul_i32 s100, s54, 11
    s_add_u32 s100, s100, s55
    s_cmp_lt_u32 s55, 11
    s_cselect_b32 s101, 1, 0
    s_cmp_lt_u32 s100, 86
    s_cselect_b32 s101, s101, 0
    s_cmp_lt_u32 s2, 128
    s_cbranch_scc1 L_role_done2
    s_lshl_b32 s100, s54, 2
    s_add_u32 s100, s100, s55
    s_cmp_lt_u32 s55, 4
    s_cselect_b32 s101, 2, 0
L_role_done2:
    s_setprio 0
    v_mov_b32 v6, 162856
L_lw_113:
    s_sleep 4
    ds_read_b32 v7, v6
    s_waitcnt lgkmcnt(0)
    v_readfirstlane_b32 s54, v7
    s_cmp_lt_u32 s54, 8
    s_cbranch_scc1 L_lw_113
    s_lshl_b32 s54, s11, 3
    s_lshl_b32 s55, s14, 1
    s_add_u32 s55, s55, s54
    s_lshl_b32 s55, s55, 14
    s_lshl_b32 s62, s10, 10
    s_add_u32 s55, s55, s62
    s_add_u32 s55, s55, 4194304
    s_add_u32 s62, s55, 16384
    buffer_store_dwordx4 v[16:19], v3, s[24:27], s55 offen sc1
    buffer_store_dwordx4 v[16:19], v3, s[24:27], s62 offen sc1
    s_and_b32 s54, s2, 7
    s_lshl_b32 s54, s54, 2
    s_bfe_u32 s55, s2, 0x20003
    s_add_u32 s54, s54, s55
    s_lshr_b32 s13, s54, 1
    s_lshl_b32 s54, s54, 2
    s_add_u32 s54, s54, s14
    s_lshl_b32 s54, s54, 14
    s_lshr_b32 s55, s2, 5
    s_lshl_b32 s55, s55, 7
    s_add_u32 s54, s54, s55
    s_add_u32 s54, s54, 6291456
    v_lshrrev_b32 v6, 3, v1
    v_and_b32 v7, 7, v1
    v_lshlrev_b32 v6, 10, v6
    v_lshl_add_u32 v6, v7, 4, v6
    s_add_u32 s55, s54, 8192
    buffer_store_dwordx4 v[16:19], v6, s[24:27], s54 offen sc1
    buffer_store_dwordx4 v[16:19], v6, s[24:27], s55 offen sc1
    s_add_u32 s54, s54, 4194304
    s_add_u32 s55, s55, 4194304
    buffer_store_dwordx4 v[16:19], v6, s[24:27], s54 offen sc1
    buffer_store_dwordx4 v[16:19], v6, s[24:27], s55 offen sc1
    s_add_u32 s54, s2, 128
    s_cmp_eq_u32 s101, 1
    s_cselect_b32 s54, s100, s54
    s_lshl_b32 s54, s54, 9
    s_lshl_b32 s55, s14, 7
    s_add_u32 s54, s54, s55
    s_add_u32 s54, s54, 9043968
    s_mov_b64 exec, 0xff
    buffer_store_dwordx4 v[16:19], v3, s[24:27], s54 offen sc1
    s_mov_b64 exec, -1
    s_cmp_lg_u32 s14, 1
    s_cbranch_scc1 L_xs_114
    s_getreg_b32 s62, hwreg(HW_REG_XCC_ID)
    s_and_b32 s54, s2, 31
    s_lshl_b32 s54, s54, 7
    s_lshr_b32 s55, s2, 5
    s_lshl_b32 s55, s55, 3
    s_add_u32 s55, s55, s54
    s_add_u32 s55, s55, 8470528
    v_mov_b32 v6, 0
    v_mov_b32 v8, s62
    v_mov_b32 v9, s52
    s_mov_b64 exec, 1
    buffer_store_dwordx2 v[8:9], v6, s[24:27], s55 offen sc1
    s_mov_b64 exec, -1
L_xs_114:
    s_lshl_b32 s63, s11, 8
    s_add_u32 s63, s63, 8454144
    s_lshl_b32 s54, s10, 2
    s_add_u32 s54, s54, s14
    s_lshl_b32 s54, s54, 2
    s_add_u32 s54, s54, s63
    v_mov_b32 v6, 0
    v_mov_b32 v7, s52
    s_waitcnt vmcnt(0)
    s_mov_b64 exec, 1
    buffer_store_dword v7, v6, s[24:27], s54 offen sc1
    s_mov_b64 exec, -1
    s_cmp_lg_u32 s14, 3
    s_cbranch_scc1 L_wk_115
    s_and_b32 s54, s2, 7
    s_lshr_b32 s55, s2, 3
    v_lshrrev_b32 v6, 2, v1
    v_and_b32 v7, 3, v1
    v_mul_u32_u24 v6, 2752, v6
    v_lshl_add_u32 v6, v7, 7, v6
    s_mul_i32 s62, s54, 352
    s_mul_i32 s3, s55, 44032
    s_add_u32 s62, s62, s3
    s_mov_b32 s32, s46
    s_and_b32 s33, s47, 0xffff
    s_mov_b32 s34, 1409024
    s_mov_b32 s35, 0x00020000
    buffer_load_dword v24, v6, s[32:35], s62 offen
    s_mov_b32 s32, s48
    s_and_b32 s33, s49, 0xffff
    s_mov_b32 s34, 1409024
    s_mov_b32 s35, 0x00020000
    buffer_load_dword v25, v6, s[32:35], s62 offen
    s_mov_b32 s32, s50
    s_and_b32 s33, s51, 0xffff
    s_mov_b32 s34, 1409024
    s_mov_b32 s35, 0x00020000
    v_min_u32 v6, 42, v1
    v_lshlrev_b32 v6, 10, v6
    s_lshl_b32 s62, s54, 7
    s_mul_i32 s3, s55, 44032
    s_add_u32 s62, s62, s3
    buffer_load_dword v26, v6, s[32:35], s62 offen
L_wk_115:
    s_mov_b32 s32, s40
    s_and_b32 s33, s41, 0xffff
    s_mov_b32 s34, 524288
    s_mov_b32 s35, 0x00020000
    v_lshrrev_b32 v6, 3, v1
    v_and_b32 v7, 7, v1
    v_lshrrev_b32 v8, 1, v7
    v_bfe_u32 v10, v6, 1, 2
    v_xor_b32 v8, v8, v10
    v_and_b32 v7, 1, v7
    v_lshlrev_b32 v7, 4, v7
    v_lshl_add_u32 v7, v8, 5, v7
    v_lshl_add_u32 v7, v6, 10, v7
    s_lshr_b32 s55, s2, 5
    s_lshl_b32 s55, s55, 7
    s_lshl_b32 s54, s14, 17
    s_add_u32 s55, s55, s54
    s_lshl_b32 s54, s14, 14
    s_mov_b32 s59, 0
L_hwo:
    s_add_u32 s62, s54, 0
    s_mov_b32 m0, s62
    s_add_u32 s3, s55, 0
    buffer_load_dwordx4 v7, s[32:35], s3 offen lds
    s_waitcnt vmcnt(3)
    s_add_u32 s62, s54, 1024
    s_mov_b32 m0, s62
    s_add_u32 s3, s55, 16384
    buffer_load_dwordx4 v7, s[32:35], s3 offen lds
    s_waitcnt vmcnt(3)
    s_add_u32 s62, s54, 2048
    s_mov_b32 m0, s62
    s_add_u32 s3, s55, 8192
    buffer_load_dwordx4 v7, s[32:35], s3 offen lds
    s_waitcnt vmcnt(3)
    s_add_u32 s62, s54, 3072
    s_mov_b32 m0, s62
    s_add_u32 s3, s55, 24576
    buffer_load_dwordx4 v7, s[32:35], s3 offen lds
    s_waitcnt vmcnt(3)
    s_add_u32 s54, s54, 4096
    s_add_u32 s55, s55, 32768
    s_add_u32 s59, s59, 1
    s_cmp_lt_u32 s59, 4
    s_cbranch_scc1 L_hwo
    v_lshrrev_b32 v6, 1, v1
    v_and_b32 v7, 3, v6
    v_bfe_u32 v8, v6, 4, 1
    v_lshl_or_b32 v7, v8, 2, v7
    v_bfe_u32 v8, v6, 2, 2
    v_lshl_or_b32 v7, v8, 3, v7
    v_and_b32 v8, 1, v1
    v_lshlrev_b32 v8, 4, v8
    s_cmp_lg_u32 s101, 1
    s_cbranch_scc1 L_hnogu
    v_mul_u32_u24 v6, 2752, v7
    v_add_u32 v6, v6, v8
    s_mov_b32 s32, s46
    s_and_b32 s33, s47, 0xffff
    s_mov_b32 s34, 1409024
    s_mov_b32 s35, 0x00020000
    s_lshl_b32 s55, s100, 5
    s_mul_i32 s54, s14, 352256
    s_add_u32 s55, s55, s54
    s_lshl_b32 s54, s14, 12
    s_add_u32 s54, s54, 120832
    s_mov_b32 s59, 0
L_hgu0:
    s_mov_b32 m0, s54
    s_add_u32 s59, s59, 1
    buffer_load_dwordx4 v6, s[32:35], s55 offen lds
    s_waitcnt vmcnt(1)
    s_add_u32 s54, s54, 1024
    s_add_u32 s55, s55, 88064
    s_cmp_lt_u32 s59, 4
    s_cbranch_scc1 L_hgu0
    s_mov_b32 s32, s48
    s_and_b32 s33, s49, 0xffff
    s_mov_b32 s34, 1409024
    s_mov_b32 s35, 0x00020000
    s_lshl_b32 s55, s100, 5
    s_mul_i32 s54, s14, 352256
    s_add_u32 s55, s55, s54
    s_lshl_b32 s54, s14, 12
    s_add_u32 s54, s54, 137216
    s_mov_b32 s59, 0
L_hgu1:
    s_mov_b32 m0, s54
    s_add_u32 s59, s59, 1
    buffer_load_dwordx4 v6, s[32:35], s55 offen lds
    s_waitcnt vmcnt(1)
    s_add_u32 s54, s54, 1024
    s_add_u32 s55, s55, 88064
    s_cmp_lt_u32 s59, 4
    s_cbranch_scc1 L_hgu1
    s_branch L_hend
L_hnogu:
    s_mov_b32 s55, s100
    s_cmp_lg_u32 s101, 2
    s_cbranch_scc1 L_hend
    v_lshlrev_b32 v6, 10, v7
    v_add_u32 v6, v6, v8
    s_lshl_b32 s55, s55, 5
    s_lshl_b32 s54, s14, 15
    s_add_u32 s55, s55, s54
    s_lshl_b32 s54, s14, 10
    s_add_u32 s54, s54, 120832
    s_mov_b32 s59, s14
    s_mov_b32 s32, s50
    s_and_b32 s33, s51, 0xffff
    s_mov_b32 s34, 1409024
    s_mov_b32 s35, 0x00020000
L_hdn:
    s_mov_b32 m0, s54
    s_add_u32 s59, s59, 4
    buffer_load_dwordx4 v6, s[32:35], s55 offen lds
    s_waitcnt vmcnt(1)
    s_add_u32 s54, s54, 4096
    s_add_u32 s55, s55, 131072
    s_cmp_lt_u32 s59, 41
    s_cbranch_scc1 L_hdn
    buffer_load_dwordx4 v[16:19], v6, s[32:35], s55 offen
L_hend:
    s_cmp_lg_u32 s14, 1
    s_cbranch_scc1 L_pxo_117
    s_getreg_b32 s62, hwreg(HW_REG_XCC_ID)
    s_and_b32 s54, s2, 31
    s_lshl_b32 s54, s54, 7
    s_add_u32 s61, s54, 8470528
    v_and_b32 v6, 7, v1
    v_lshlrev_b32 v6, 3, v6
L_px_116:
    s_cmp_eq_u32 s53, 0
    s_cbranch_scc1 L_pxo_117
    s_sub_u32 s53, s53, 1
    buffer_load_dwordx2 v[8:9], v6, s[24:27], s61 offen sc1
    s_waitcnt vmcnt(0)
    v_cmp_eq_u32 vcc, s52, v9
    s_cmp_eq_u64 vcc, exec
    s_cbranch_scc0 L_px_116
    v_cmp_eq_u32 vcc, s62, v8
    s_cmp_eq_u64 vcc, exec
    s_cselect_b32 s54, 1, 0
    v_mov_b32 v6, 162864
    v_mov_b32 v7, s54
    ds_write_b32 v6, v7
    s_waitcnt lgkmcnt(0)
L_pxo_117:
    s_cmp_lg_u32 s14, 2
    s_cbranch_scc1 L_tch_118
    s_mov_b32 s32, s44
    s_and_b32 s33, s45, 0xffff
    s_mov_b32 s34, 1024
    s_mov_b32 s35, 0x00020000
    s_mov_b32 s28, s4
    s_and_b32 s29, s5, 0xffff
    s_mov_b32 s30, 2097152
    s_mov_b32 s31, 0x00020000
    buffer_load_dwordx4 v[16:19], v3, s[32:35], 0 offen
    s_lshl_b32 s54, s2, 13
    buffer_load_dword v20, v3, s[28:31], s54 offen
    s_and_b32 s54, s2, 7
    s_lshl_b32 s54, s54, 2
    s_bfe_u32 s55, s2, 0x20003
    s_add_u32 s54, s54, s55
    s_lshl_b32 s54, s54, 16
    s_lshr_b32 s55, s2, 5
    s_lshl_b32 s55, s55, 7
    s_add_u32 s54, s54, s55
    v_lshlrev_b32 v6, 10, v1
    buffer_load_dword v21, v6, s[16:19], s54 offen
L_tch_118:
    s_cmp_lg_u32 s14, 0
    s_cbranch_scc1 L_pco_120
    s_lshl_b32 s63, s13, 8
    s_add_u32 s63, s63, 8454144
    v_lshlrev_b32 v6, 2, v1
L_pc_119:
    s_cmp_eq_u32 s53, 0
    s_cbranch_scc1 L_pco_120
    s_sub_u32 s53, s53, 1
    buffer_load_dword v7, v6, s[24:27], s63 offen sc1
    s_waitcnt vmcnt(0)
    v_cmp_eq_u32 vcc, s52, v7
    s_cmp_eq_u64 vcc, exec
    s_cbranch_scc1 L_pco_120
    s_sleep 8
    s_branch L_pc_119
L_pco_120:
    s_waitcnt vmcnt(0)
    s_endpgm
L_code_end:
.section .rodata,"a"
.p2align 6
.amdhsa_kernel sequential_preLN__mha_block__moe_arch_mod__prompt_kernel
  .amdhsa_next_free_vgpr 168
  .amdhsa_next_free_sgpr 102
  .amdhsa_accum_offset 168
  .amdhsa_group_segment_fixed_size 0
  .amdhsa_kernarg_size 88
  .amdhsa_user_sgpr_count 2
  .amdhsa_user_sgpr_kernarg_segment_ptr 1
  .amdhsa_system_sgpr_workgroup_id_x 1
.end_amdhsa_kernel
```
